```python
import torch

def _softmax(x, axis=-1):
    return torch.softmax(x, dim=axis)
def _gelu(x):
    return torch.nn.functional.gelu(x, approximate="tanh")
def _silu(x):
    return torch.nn.functional.silu(x)
def _sigmoid(x):
    return torch.sigmoid(x)
def _layernorm(x, axis=-1, eps=1e-5):
    m = x.mean(dim=axis, keepdim=True)
    v = x.var(dim=axis, keepdim=True, unbiased=False)
    return (x - m) / torch.sqrt(v + eps)
def _scatter_add(tgt, idx, src, axis=0):
    return tgt.clone().index_add_(axis, idx, src)
def _segment_sum(src, seg, n):
    out = torch.zeros((n,) + src.shape[1:], dtype=src.dtype)
    return out.index_add_(0, seg, src)
def _pad(x, pw):
    flat = tuple(v for pair in reversed(pw) for v in pair)
    return torch.nn.functional.pad(x, flat)

kernel_name = 'concat_heads__sliding_block__ssm_conv_h3__prompt'

def setup_inputs():

    _w = (lambda a: (lambda t: t.to(torch.bfloat16) if t.is_floating_point() else t)(torch.as_tensor(a)))
    def _A_setup():
        B, S, D = 1, 2048, 512
        return {
            "x": _w((lambda *s: torch.randn(*s, dtype=torch.bfloat16) * 0.4)(B, S, D)),
            "wqkv": _w((lambda *s: torch.randn(*s, dtype=torch.bfloat16) * 0.4)(D, 3 * D)),
            "wo": _w((lambda *s: torch.randn(*s, dtype=torch.bfloat16) * 0.05)(D, D)),
        }
    _A_in = _A_setup()

    def _B_setup():
        B, S, D = 1, 2048, 512
        ks = 4
        return {
            "q": _w((lambda *s: torch.randn(*s, dtype=torch.bfloat16) * 0.05)(B, S, D)),
            "k": _w((lambda *s: torch.randn(*s, dtype=torch.bfloat16) * 1.6)(B, S, D)),
            "v": _w((lambda *s: torch.randn(*s, dtype=torch.bfloat16) * 1.6)(B, S, D)),
            "shift_k": _w((lambda *s: torch.randn(*s, dtype=torch.bfloat16) * 1.6)(D, ks) * 0.5),
            "ssm_k": _w((lambda *s: torch.randn(*s, dtype=torch.bfloat16) * 3.2)(D, S) * (1.0 / S ** 0.5)),
            "ssm_D": _w((lambda *s: torch.randn(*s, dtype=torch.bfloat16) * 1.6)(D)),
        }
    _B_in = _B_setup()

    return {
        "A_x": _A_in["x"],
        "A_wqkv": _A_in["wqkv"],
        "A_wo": _A_in["wo"],
        "B_q": _B_in["q"],
        "B_k": _B_in["k"],
        "B_v": _B_in["v"],
        "B_shift_k": _B_in["shift_k"],
        "B_ssm_k": _B_in["ssm_k"],
        "B_ssm_D": _B_in["ssm_D"],
    }

def reference(A_x, A_wqkv, A_wo, B_q, B_k, B_v, B_shift_k, B_ssm_k, B_ssm_D):
    def _A_ref(x, wqkv, wo):
        B, S, D = x.shape
        H = 32; Dh = D // H; W = 256
        qkv = (lambda x, *d: x.permute(*d))((x @ wqkv).reshape(B, S, 3, H, Dh), 2, 0, 3, 1, 4)
        q, k, v = qkv[0], qkv[1], qkv[2]
        scores = torch.einsum("bhqd,bhkd->bhqk", q, k) * (Dh ** -0.5)
        idx = torch.arange(S)
        mask = (idx[:, None] - idx[None, :] >= 0) & (idx[:, None] - idx[None, :] < W)
        scores = torch.where(mask[None, None], scores, -1e9)
        p = _softmax(scores, axis=-1)
        o = torch.einsum("bhqk,bhkd->bhqd", p, v)
        return (lambda x, *d: x.permute(*d))(o, 0, 2, 1, 3).reshape(B, S, D) @ wo

    def _B_ref(q, k, v, shift_k, ssm_k, ssm_D):
        B, S, D = q.shape
        ks = shift_k.shape[-1]
        k_pad = _pad(k, ((0, 0), (ks - 1, 0), (0, 0)))
        k_shift = torch.zeros_like(k)
        for t in range(ks):
            k_shift = k_shift + k_pad[:, t:t + S, :] * shift_k[:, ks - 1 - t][None, None, :]
        kv = k_shift * v
        L = 2 * S
        kv_pad = _pad(kv, ((0, 0), (0, S), (0, 0)))
        kf_pad = _pad(ssm_k, ((0, 0), (0, S)))
        kv_f = (lambda x, axes=(-2,-1): torch.fft.rfft2(x.float(), dim=axes))(kv_pad[:, None, :, :], axes=(1, 2))
        kf_f = (lambda x, axes=(-2,-1): torch.fft.rfft2(x.float(), dim=axes))(kf_pad[:, None, :], axes=(1, 2))
        kf_f = (lambda x, *d: x.permute(*d))(kf_f, 1, 2, 0)
        y_f = kv_f * kf_f[None, :, :, :]
        y = (lambda x, s, axes=(-2,-1): torch.fft.irfft2(x, s=s, dim=axes).to(torch.bfloat16))(y_f, (1, L), axes=(1, 2))[:, 0, :S, :]
        y = y + kv * ssm_D[None, None, :]
        return q * y

    a = _A_ref(A_x, A_wqkv, A_wo)
    b = _B_ref(B_q, B_k, B_v, B_shift_k, B_ssm_k, B_ssm_D)
    return torch.concatenate([a, b], axis=-1)
```

```asm
; @launch grid=(256,1,1) block=(256,1,1) lds=150016
.amdgcn_target "amdgcn-amd-amdhsa--gfx950"
.text
.globl concat_heads__sliding_block__ssm_conv_h3__prompt_kernel
.p2align 8
.type concat_heads__sliding_block__ssm_conv_h3__prompt_kernel,@function
concat_heads__sliding_block__ssm_conv_h3__prompt_kernel:
L_entry:
    s_load_dwordx16 s[56:71], s[0:1], 0
    s_load_dwordx8 s[72:79], s[0:1], 64
    s_memrealtime s[52:53]
    s_cmp_ge_u32 s2, 256
    s_cbranch_scc1 L_end
    s_getpc_b64 s[8:9]
L_pc:
    s_sub_u32 s8, s8, (L_pc - L_entry)
    s_subb_u32 s9, s9, 0
    s_mov_b32 s10, (L_codeend - L_entry)
    s_mov_b32 s11, 0x20000
    s_lshr_b32 s5, s2, 3
    s_and_b32 s84, s5, 7
    s_lshl_b32 s84, s84, 12
    v_lshlrev_b32 v2, 4, v0
    buffer_load_dwordx4 v[216:219], v2, s[8:11], s84 offen
    v_and_b32 v1, 63, v0
    v_lshrrev_b32 v2, 6, v0
    s_and_b32 s4, s2, 7
    v_readfirstlane_b32 s3, v2
    v_and_b32 v4, 7, v1
    v_lshrrev_b32 v5, 3, v1
    s_lshl_b32 s84, s5, 6
    s_lshl_b32 s86, s4, 7
    s_lshl_b32 s85, s3, 4
    s_add_u32 s84, s84, s85
    s_lshl_b32 s84, s84, 10
    s_add_u32 s84, s84, s86
    v_lshlrev_b32 v140, 11, v5
    v_lshl_add_u32 v140, v4, 4, v140
    v_add_u32 v140, s84, v140
    v_subrev_u32 v141, 3072, v140
    v_subrev_u32 v142, 2048, v140
    v_subrev_u32 v143, 1024, v140
    s_lshr_b32 s84, s4, 1
    s_lshl_b32 s84, s84, 3
    s_lshr_b32 s85, s5, 2
    s_add_u32 s6, s84, s85
    s_and_b32 s84, s4, 1
    s_lshl_b32 s84, s84, 2
    s_and_b32 s85, s5, 3
    s_add_u32 s7, s84, s85
    s_lshl_b32 s84, s4, 9
    v_lshlrev_b32 v13, 4, v1
    v_add_u32 v144, s84, v13
    v_lshrrev_b32 v2, 4, v1
    v_xor_b32 v3, v4, v2
    v_lshlrev_b32 v3, 4, v3
    s_lshl_b32 s84, s3, 14
    v_lshl_add_u32 v100, v5, 10, v3
    v_add_u32 v100, s84, v100
    v_xor_b32 v101, 64, v100
    v_add_u32 v101, 7168, v101
    v_lshrrev_b32 v3, 1, v4
    v_and_b32 v2, 1, v2
    v_lshlrev_b32 v2, 1, v2
    v_xor_b32 v3, v3, v2
    v_lshlrev_b32 v3, 5, v3
    v_and_b32 v2, 1, v4
    v_lshl_add_u32 v3, v2, 4, v3
    v_mul_u32_u24 v102, 3072, v5
    v_add_u32 v102, v102, v3
    v_xor_b32 v103, 32, v102
    v_add_u32 v248, 24576, v102
    v_add_u32 v249, 24576, v103
    s_lshl_b32 s80, s6, 16
    s_mul_i32 s81, s3, 49152
    s_lshl_b32 s84, s7, 7
    s_add_u32 s81, s81, s84
    s_lshl_b32 s82, s3, 11
    s_mul_i32 s98, s3, 6144
    s_add_u32 s98, s98, 8192
    s_waitcnt lgkmcnt(0)
    s_mov_b32 s16, s64
    s_mov_b32 s17, s65
    s_mov_b32 s18, 2097152
    s_mov_b32 s19, 0x20000
    s_mov_b32 s20, s66
    s_mov_b32 s21, s67
    s_mov_b32 s22, 2097152
    s_mov_b32 s23, 0x20000
    s_mov_b32 s8, s56
    s_mov_b32 s9, s57
    s_mov_b32 s10, 2097152
    s_mov_b32 s11, 0x20000
    s_mov_b32 s12, s58
    s_mov_b32 s13, s59
    s_mov_b32 s14, 1572864
    s_mov_b32 s15, 0x20000
    s_or_b32 s84, s2, s3
    s_cmp_lg_u32 s84, 0
    s_cbranch_scc1 L_nononce_1
    s_mov_b32 s44, s76
    s_mov_b32 s45, s77
    s_mov_b32 s46, 256
    s_mov_b32 s47, 0x20000
    s_or_b32 s53, s53, 0x80000000
    v_mov_b32 v14, s52
    v_mov_b32 v15, s53
    v_mov_b32 v2, 0
    s_mov_b64 exec, 1
    buffer_store_dwordx2 v[14:15], v2, s[44:47], 0 offen sc1
    s_mov_b64 exec, -1
L_nononce_1:
    buffer_load_dwordx4 v[28:31], v140, s[16:19], 0 offen offset:0 nt
    buffer_load_dwordx4 v[32:35], v140, s[16:19], 0 offen offset:1024 nt
    buffer_load_dwordx4 v[24:27], v143, s[16:19], 0 offen offset:0 nt
    buffer_load_dwordx4 v[20:23], v142, s[16:19], 0 offen offset:0 nt
    buffer_load_dwordx4 v[16:19], v141, s[16:19], 0 offen offset:0 nt
    buffer_load_dwordx4 v[36:39], v140, s[20:23], 0 offen offset:0 nt
    buffer_load_dwordx4 v[40:43], v140, s[20:23], 0 offen offset:1024 nt
    s_mov_b32 s48, s68
    s_mov_b32 s49, s69
    s_mov_b32 s50, 4096
    s_mov_b32 s51, 0x20000
    s_mov_b32 m0, 148992
    s_mov_b32 exec_hi, 0
    buffer_load_dwordx4 v144, s[48:51], 0 offen lds
    s_mov_b32 exec_hi, -1
    s_add_u32 m0, s82, 0
    s_add_u32 s93, s80, 0
    buffer_load_dwordx4 v100, s[8:11], s93 offen lds
    buffer_load_dwordx4 v101, s[8:11], s93 offen offset:1024 lds
    s_add_u32 m0, s98, 0
    s_add_u32 s92, s81, 0
    buffer_load_dwordx4 v102, s[12:15], s92 offen lds
    buffer_load_dwordx4 v103, s[12:15], s92 offen offset:1024 lds
    buffer_load_dwordx4 v102, s[12:15], s92 offen offset:2048 lds
    s_add_u32 m0, s98, 3072
    s_nop 0
    buffer_load_dwordx4 v248, s[12:15], s92 offen lds
    buffer_load_dwordx4 v249, s[12:15], s92 offen offset:1024 lds
    buffer_load_dwordx4 v248, s[12:15], s92 offen offset:2048 lds
    s_lshr_b32 s84, s6, 3
    s_lshl_b32 s84, s84, 9
    s_lshl_b32 s85, s5, 4
    s_add_u32 s84, s84, s85
    s_lshl_b32 s85, s3, 2
    s_add_u32 s88, s84, s85
    s_lshl_b32 s88, s88, 10
    v_lshlrev_b32 v145, 10, v5
    v_lshl_add_u32 v145, v4, 6, v145
    v_add_u32 v145, s88, v145
    s_lshl_b32 s84, s5, 3
    s_lshl_b32 s85, s3, 1
    s_add_u32 s84, s84, s85
    s_mul_i32 s84, s84, 3072
    s_lshr_b32 s85, s7, 2
    s_lshl_b32 s85, s85, 9
    s_add_u32 s84, s84, s85
    v_subrev_u32 v7, 24, v1
    v_ashrrev_i32 v3, 31, v7
    v_and_b32 v6, 24, v3
    v_add_u32 v7, v7, v6
    v_not_b32 v3, v3
    v_and_b32 v3, 3072, v3
    v_lshrrev_b32 v6, 3, v7
    v_lshl_add_u32 v3, v6, 10, v3
    v_and_b32 v7, 7, v7
    v_lshl_add_u32 v3, v7, 6, v3
    v_add_u32 v146, s84, v3
    s_mov_b32 exec_hi, 0xffff
    buffer_load_dword v252, v146, s[12:15], 0 offen
    s_mov_b32 exec_hi, 0
    buffer_load_dword v252, v145, s[8:11], 0 offen
    s_mov_b32 exec_hi, -1
    s_mov_b32 s40, s78
    s_mov_b32 s41, s79
    s_mov_b32 s42, 12845056
    s_mov_b32 s43, 0x20000
    s_mov_b32 s44, s76
    s_mov_b32 s45, s77
    s_mov_b32 s46, 256
    s_mov_b32 s47, 0x20000
    s_mov_b32 s24, s62
    s_mov_b32 s25, s63
    s_mov_b32 s26, 2097152
    s_mov_b32 s27, 0x20000
    s_mov_b32 s32, s60
    s_mov_b32 s33, s61
    s_mov_b32 s34, 524288
    s_mov_b32 s35, 0x20000
    s_mov_b32 s36, s74
    s_mov_b32 s37, s75
    s_mov_b32 s38, 4194304
    s_mov_b32 s39, 0x20000
    s_lshl_b32 s84, s4, 7
    s_lshl_b32 s85, s5, 2
    s_add_u32 s84, s84, s85
    s_load_dword s54, s[72:73], s84
    s_lshl_b32 s84, s4, 6
    s_lshl_b32 s85, s5, 1
    s_add_u32 s84, s84, s85
    s_lshr_b32 s85, s3, 1
    s_add_u32 s87, s84, s85
    s_lshl_b32 s84, s87, 12
    s_add_u32 s28, s70, s84
    s_addc_u32 s29, s71, 0
    s_mov_b32 s30, 4096
    s_mov_b32 s31, 0x20000
    s_mov_b32 s70, s87
    s_and_b32 s71, s3, 1
    s_load_dwordx8 s[72:79], s[28:29], 4064
    s_min_u32 s83, s6, 4
    s_lshl_b32 s95, s7, 2
    s_add_u32 s95, s95, s3
    s_mov_b32 s94, 0
    s_mov_b32 s96, 0x05040100
    s_mov_b32 s97, 0x07060302
    v_and_b32 v2, 31, v1
    v_lshrrev_b32 v3, 5, v1
    v_bfe_u32 v6, v2, 1, 3
    v_xor_b32 v3, v3, v6
    v_lshlrev_b32 v2, 7, v2
    v_xor_b32 v6, 0, v3
    v_lshl_add_u32 v104, v6, 4, v2
    v_add_u32 v108, 0x10000, v104
    v_xor_b32 v6, 2, v3
    v_lshl_add_u32 v105, v6, 4, v2
    v_add_u32 v109, 0x10000, v105
    v_xor_b32 v6, 4, v3
    v_lshl_add_u32 v106, v6, 4, v2
    v_add_u32 v110, 0x10000, v106
    v_xor_b32 v6, 6, v3
    v_lshl_add_u32 v107, v6, 4, v2
    v_add_u32 v111, 0x10000, v107
    v_bfe_u32 v2, v1, 4, 1
    v_lshrrev_b32 v3, 5, v1
    v_bfe_u32 v6, v1, 2, 2
    v_mul_u32_u24 v7, 3072, v3
    v_lshl_add_u32 v7, v6, 7, v7
    v_and_b32 v9, 3, v1
    v_lshl_add_u32 v7, v9, 3, v7
    v_and_b32 v9, 2, v6
    v_xor_b32 v9, s3, v9
    v_lshl_add_u32 v113, v9, 5, v7
    v_add_u32 v113, 10240, v113
    v_xor_b32 v9, v9, v2
    v_lshl_add_u32 v112, v9, 5, v7
    v_lshl_add_u32 v112, v2, 10, v112
    v_add_u32 v112, 8192, v112
    v_add_u32 v114, 0x10000, v112
    v_add_u32 v115, 0x10000, v113
    s_lshl_b32 s84, s3, 3
    v_add_u32 v2, s84, v5
    v_sub_u32 v2, 31, v2
    v_lshrrev_b32 v3, 2, v2
    v_xor_b32 v3, v3, v4
    v_lshlrev_b32 v3, 4, v3
    v_and_b32 v2, 3, v2
    v_lshl_add_u32 v3, v2, 2, v3
    v_lshl_add_u32 v3, v4, 10, v3
    v_add_u32 v155, 140800, v3
    v_lshlrev_b32 v153, 6, v4
    v_add_u32 v153, 148992, v153
    s_lshl_b32 s84, s3, 1
    v_xor_b32 v156, s84, v4
    v_lshlrev_b32 v156, 4, v156
    v_lshl_add_u32 v156, v5, 7, v156
    s_lshl_b32 s85, s3, 11
    s_add_u32 s85, s85, 140800
    v_add_u32 v156, s85, v156
    v_xor_b32 v157, 16, v156
    s_lshl_b32 s84, s4, 6
    s_lshl_b32 s85, s3, 4
    s_add_u32 s84, s84, s85
    s_lshl_b32 s84, s84, 12
    s_lshl_b32 s85, s5, 7
    s_sub_u32 s84, s84, s85
    s_add_u32 s84, s84, 1052544
    v_lshlrev_b32 v158, 12, v5
    v_lshl_add_u32 v158, v4, 4, v158
    v_add_u32 v158, s84, v158
    v_add_u32 v159, 32768, v158
    v_cmp_eq_u32 vcc, 0, v1
    v_mov_b32 v2, 0x7ff00000
    v_mov_b32 v3, 0
    v_cndmask_b32 v10, v2, v3, vcc
    v_lshlrev_b32 v7, 4, v1
    v_cmp_gt_u32 vcc, 32, v1
    s_nop 1
    v_cndmask_b32 v7, v2, v7, vcc
    s_lshl_b32 s84, s71, 11
    v_lshlrev_b32 v138, 5, v1
    v_add_u32 v138, s84, v138
    v_subrev_u32 v136, 32, v138
    v_subrev_u32 v137, 16, v138
    s_lshr_b32 s85, s3, 1
    s_mul_i32 s86, s85, 16640
    s_add_u32 s84, s84, s86
    s_add_u32 s84, s84, 98304
    v_lshlrev_b32 v132, 5, v1
    v_add_u32 v132, s84, v132
    s_add_u32 s86, s86, 102400
    v_mov_b32 v139, s86
    s_lshl_b32 s67, s70, 12
    s_lshl_b32 s84, s71, 10
    s_add_u32 s67, s67, s84
    s_add_u32 s67, s67, 1048576
    s_mul_i32 s86, s85, 4608
    s_add_u32 s86, s86, s84
    s_add_u32 s86, s86, 131584
    v_add_u32 v127, s86, v13
    v_mov_b32 v148, 0
    v_mov_b32 v149, 0
    v_mov_b32 v150, 0
    v_mov_b32 v151, 0
    v_lshrrev_b32 v2, 5, v1
    v_mul_u32_u24 v2, 4608, v2
    v_and_b32 v3, 31, v1
    v_lshl_add_u32 v2, v3, 4, v2
    v_add_u32 v152, 135680, v2
    v_and_b32 v4, 15, v1
    v_lshrrev_b32 v5, 4, v1
    v_add_u32 v2, 1, v4
    v_and_b32 v3, 3, v2
    v_lshrrev_b32 v2, 2, v2
    v_mul_u32_u24 v14, 4160, v3
    v_lshl_add_u32 v14, v2, 3, v14
    v_lshl_add_u32 v14, v5, 4, v14
    s_lshr_b32 s84, s3, 1
    s_mul_i32 s85, s84, 16640
    s_lshl_b32 s86, s71, 8
    s_add_u32 s85, s85, s86
    s_add_u32 s85, s85, 98304
    v_add_u32 v14, s85, v14
    s_mul_i32 s85, s84, 4608
    s_add_u32 s85, s85, s86
    s_add_u32 s85, s85, 132064
    v_lshlrev_b32 v15, 4, v5
    v_lshlrev_b32 v2, 5, v4
    v_sub_u32 v15, v15, v2
    v_add_u32 v15, s85, v15
    v_lshrrev_b32 v2, 5, v1
    v_mul_u32_u24 v2, 17, v2
    v_and_b32 v3, 31, v1
    v_add_u32 v2, v2, v3
    v_lshlrev_b32 v11, 4, v2
    v_sub_u32 v3, 16, v3
    v_ashrrev_i32 v3, 31, v3
    v_and_b32 v3, 0x7ff00000, v3
    v_or_b32 v11, v11, v3
    v_bfe_u32 v12, v1, 4, 1
    v_lshlrev_b32 v12, 14, v12
    v_lshrrev_b32 v2, 5, v1
    v_lshl_add_u32 v12, v2, 8, v12
    v_and_b32 v2, 15, v1
    v_lshl_add_u32 v12, v2, 4, v12
    s_lshl_b32 s99, s6, 16
    s_lshr_b32 s85, s95, 1
    s_lshl_b32 s85, s85, 10
    s_add_u32 s99, s99, s85
    s_and_b32 s85, s95, 1
    s_lshl_b32 s85, s85, 9
    s_add_u32 s99, s99, s85
    s_add_u32 s99, s99, 10485760
    v_mov_b32 v128, -1
    v_mov_b32 v129, -1
    v_mov_b32 v130, -1
    v_mov_b32 v131, -1
    s_lshl_b32 s68, 1, s83
    s_sub_u32 s68, s68, 1
    s_lshl_b32 s84, s95, 6
    s_lshl_b32 s85, s6, 1
    s_add_u32 s84, s84, s85
    s_mul_i32 s56, s84, 2304
    s_add_u32 s56, s56, 5242880
    s_lshl_b32 s57, s70, 12
    s_lshl_b32 s84, s71, 11
    s_add_u32 s57, s57, s84
    s_add_u32 s57, s57, 3145728
    s_lshl_b32 s84, s4, 6
    s_lshl_b32 s85, s3, 4
    s_add_u32 s84, s84, s85
    s_lshl_b32 s84, s84, 12
    s_lshl_b32 s86, s5, 7
    s_add_u32 s84, s84, s86
    s_add_u32 s58, s84, 3145728
    s_lshl_b32 s84, s5, 6
    s_add_u32 s84, s84, s85
    s_lshl_b32 s86, s4, 7
    s_lshl_b32 s62, s84, 10
    s_add_u32 s62, s62, s86
    s_lshl_b32 s59, s84, 11
    s_add_u32 s59, s59, s86
    s_add_u32 s59, s59, 1024
    s_lshl_b32 s84, s6, 6
    s_add_u32 s84, s84, s85
    s_lshl_b32 s60, s84, 11
    s_lshl_b32 s86, s7, 7
    s_add_u32 s60, s60, s86
    s_lshl_b32 s61, s6, 2
    s_add_u32 s61, s61, s3
    s_lshl_b32 s61, s61, 14
    s_add_u32 s61, s61, 10485760
    s_lshl_b32 s63, s3, 17
    s_add_u32 s63, s63, s86
    s_lshl_b32 s66, s3, 14
    s_lshl_b32 s84, s4, 2
    s_add_u32 s84, s84, s3
    s_lshl_b32 s84, s84, 5
    s_add_u32 s84, s84, s5
    s_lshl_b32 s16, s84, 4
    s_lshl_b32 s84, s4, 2
    s_lshr_b32 s85, s5, 3
    s_add_u32 s84, s84, s85
    s_lshl_b32 s20, s84, 9
    s_mul_i32 s84, s95, 32
    s_add_u32 s84, s84, s6
    s_lshl_b32 s17, s84, 4
    s_add_u32 s17, s17, 131072
    s_lshl_b32 s85, s83, 4
    s_sub_u32 s21, s17, s85
    s_lshl_b32 s84, s6, 5
    s_add_u32 s85, s84, s95
    s_lshl_b32 s18, s85, 4
    s_add_u32 s18, s18, 393216
    s_lshl_b32 s23, s84, 4
    s_add_u32 s23, s23, 393216
    s_lshl_b32 s84, s4, 1
    s_add_u32 s85, s84, s71
    s_lshl_b32 s85, s85, 6
    s_and_b32 s86, s70, 63
    s_add_u32 s85, s85, s86
    s_lshl_b32 s19, s85, 4
    s_add_u32 s19, s19, 262144
    s_lshr_b32 s85, s5, 4
    s_add_u32 s84, s84, s85
    s_lshl_b32 s84, s84, 6
    s_lshl_b32 s85, s3, 4
    s_add_u32 s84, s84, s85
    s_lshl_b32 s22, s84, 4
    s_add_u32 s22, s22, 262144
    s_waitcnt lgkmcnt(0)
    v_mov_b32 v116, s72
    v_mov_b32 v117, s73
    v_mov_b32 v118, s74
    v_mov_b32 v119, s75
    v_mov_b32 v120, s76
    v_mov_b32 v121, s77
    v_mov_b32 v122, s78
    v_mov_b32 v123, s79
    v_mov_b32 v124, 0
    v_mov_b32 v125, 0
    v_alignbit_b32 v224, v117, v116, 16
    v_alignbit_b32 v225, v118, v117, 16
    v_alignbit_b32 v226, v119, v118, 16
    v_alignbit_b32 v227, v120, v119, 16
    v_alignbit_b32 v228, v121, v120, 16
    v_alignbit_b32 v229, v122, v121, 16
    v_alignbit_b32 v230, v123, v122, 16
    v_alignbit_b32 v231, v124, v123, 16
    v_mov_b32 v232, v117
    v_mov_b32 v233, v118
    v_mov_b32 v234, v119
    v_mov_b32 v235, v120
    v_mov_b32 v236, v121
    v_mov_b32 v237, v122
    v_mov_b32 v238, v123
    v_mov_b32 v239, v124
    v_alignbit_b32 v240, v118, v117, 16
    v_alignbit_b32 v241, v119, v118, 16
    v_alignbit_b32 v242, v120, v119, 16
    v_alignbit_b32 v243, v121, v120, 16
    v_alignbit_b32 v244, v122, v121, 16
    v_alignbit_b32 v245, v123, v122, 16
    v_alignbit_b32 v246, v124, v123, 16
    v_alignbit_b32 v247, v125, v124, 16
    ds_write_b128 v152, v[148:151]
    s_mov_b64 exec, 1
    ds_write_b128 v139, v[116:119]
    ds_write_b128 v139, v[120:123] offset:16
    ds_write_b128 v139, v[224:227] offset:4160
    ds_write_b128 v139, v[228:231] offset:4176
    ds_write_b128 v139, v[232:235] offset:8320
    ds_write_b128 v139, v[236:239] offset:8336
    ds_write_b128 v139, v[240:243] offset:12480
    ds_write_b128 v139, v[244:247] offset:12496
    s_mov_b64 exec, -1
    s_lshl_b32 s84, s54, 16
    s_and_b32 s85, s54, 0xffff0000
    s_cmp_lt_u32 s3, 2
    s_cselect_b32 s69, s84, s85
    s_waitcnt lgkmcnt(0)
    s_mov_b32 exec_hi, 0
    buffer_load_dword v252, v145, s[8:11], 0 offen offset:512
    s_mov_b32 exec_hi, 0xffff
    s_mov_b32 s86, 786432
    buffer_load_dword v252, v146, s[12:15], s86 offen
    s_mov_b32 exec_hi, -1
    s_lshl_b32 s86, s71, 11
    v_lshlrev_b32 v2, 6, v1
    s_mov_b32 exec_hi, 0
    buffer_load_dword v252, v2, s[28:31], s86 offen nt
    s_mov_b64 exec, -1
    s_waitcnt vmcnt(13)
    ds_read_b128 v[44:47], v153 offset:0
    ds_read_b128 v[48:51], v153 offset:16
    ds_read_b128 v[52:55], v153 offset:32
    ds_read_b128 v[56:59], v153 offset:48
    v_perm_b32 v224, v24, v28, s96
    v_perm_b32 v225, v28, v32, s96
    v_perm_b32 v226, v16, v20, s96
    v_perm_b32 v227, v20, v24, s96
    v_lshlrev_b32 v228, 16, v36
    v_lshlrev_b32 v229, 16, v40
    v_perm_b32 v232, v24, v28, s97
    v_perm_b32 v233, v28, v32, s97
    v_perm_b32 v234, v16, v20, s97
    v_perm_b32 v235, v20, v24, s97
    v_and_b32 v236, 0xffff0000, v36
    v_and_b32 v237, 0xffff0000, v40
    s_add_u32 m0, s82, 32768
    s_add_u32 s93, s80, 128
    buffer_load_dwordx4 v100, s[8:11], s93 offen lds
    s_waitcnt lgkmcnt(0)
    v_dot2_f32_bf16 v230, v224, v44, 0
    v_dot2_f32_bf16 v231, v225, v44, 0
    v_dot2_f32_bf16 v230, v226, v45, v230
    v_dot2_f32_bf16 v231, v227, v45, v231
    v_dot2_f32_bf16 v238, v232, v46, 0
    v_dot2_f32_bf16 v239, v233, v46, 0
    v_dot2_f32_bf16 v238, v234, v47, v238
    v_dot2_f32_bf16 v239, v235, v47, v239
    v_mul_f32 v230, v230, v228
    v_mul_f32 v231, v231, v229
    v_mul_f32 v238, v238, v236
    buffer_load_dwordx4 v101, s[8:11], s93 offen offset:1024 lds
    v_mul_f32 v239, v239, v237
    v_cvt_pk_bf16_f32 v92, v231, v230
    v_cvt_pk_bf16_f32 v93, v239, v238
    v_perm_b32 v240, v25, v29, s96
    v_perm_b32 v241, v29, v33, s96
    v_perm_b32 v242, v17, v21, s96
    v_perm_b32 v243, v21, v25, s96
    v_lshlrev_b32 v244, 16, v37
    v_lshlrev_b32 v245, 16, v41
    v_perm_b32 v224, v25, v29, s97
    v_perm_b32 v225, v29, v33, s97
    v_perm_b32 v226, v17, v21, s97
    s_add_u32 m0, s98, 32768
    s_add_u32 s92, s81, 196608
    buffer_load_dwordx4 v102, s[12:15], s92 offen lds
    v_perm_b32 v227, v21, v25, s97
    v_and_b32 v228, 0xffff0000, v37
    v_and_b32 v229, 0xffff0000, v41
    v_dot2_f32_bf16 v246, v240, v48, 0
    v_dot2_f32_bf16 v247, v241, v48, 0
    v_dot2_f32_bf16 v246, v242, v49, v246
    v_dot2_f32_bf16 v247, v243, v49, v247
    v_dot2_f32_bf16 v230, v224, v50, 0
    v_dot2_f32_bf16 v231, v225, v50, 0
    v_dot2_f32_bf16 v230, v226, v51, v230
    v_dot2_f32_bf16 v231, v227, v51, v231
    v_mul_f32 v246, v246, v244
    buffer_load_dwordx4 v103, s[12:15], s92 offen offset:1024 lds
    v_mul_f32 v247, v247, v245
    v_mul_f32 v230, v230, v228
    v_mul_f32 v231, v231, v229
    v_cvt_pk_bf16_f32 v94, v247, v246
    v_cvt_pk_bf16_f32 v95, v231, v230
    v_perm_b32 v232, v26, v30, s96
    v_perm_b32 v233, v30, v34, s96
    v_perm_b32 v234, v18, v22, s96
    v_perm_b32 v235, v22, v26, s96
    v_lshlrev_b32 v236, 16, v38
    v_lshlrev_b32 v237, 16, v42
    v_perm_b32 v240, v26, v30, s97
    buffer_load_dwordx4 v102, s[12:15], s92 offen offset:2048 lds
    s_add_u32 m0, s98, 35840
    v_perm_b32 v241, v30, v34, s97
    v_perm_b32 v242, v18, v22, s97
    v_perm_b32 v243, v22, v26, s97
    v_and_b32 v244, 0xffff0000, v38
    v_and_b32 v245, 0xffff0000, v42
    v_dot2_f32_bf16 v238, v232, v52, 0
    v_dot2_f32_bf16 v239, v233, v52, 0
    v_dot2_f32_bf16 v238, v234, v53, v238
    v_dot2_f32_bf16 v239, v235, v53, v239
    v_dot2_f32_bf16 v246, v240, v54, 0
    v_dot2_f32_bf16 v247, v241, v54, 0
    v_dot2_f32_bf16 v246, v242, v55, v246
    s_nop 0
    buffer_load_dwordx4 v248, s[12:15], s92 offen lds
    v_dot2_f32_bf16 v247, v243, v55, v247
    v_mul_f32 v238, v238, v236
    v_mul_f32 v239, v239, v237
    v_mul_f32 v246, v246, v244
    v_mul_f32 v247, v247, v245
    v_cvt_pk_bf16_f32 v96, v239, v238
    v_cvt_pk_bf16_f32 v97, v247, v246
    v_perm_b32 v224, v27, v31, s96
    v_perm_b32 v225, v31, v35, s96
    v_perm_b32 v226, v19, v23, s96
    v_perm_b32 v227, v23, v27, s96
    v_lshlrev_b32 v228, 16, v39
    buffer_load_dwordx4 v249, s[12:15], s92 offen offset:1024 lds
    v_lshlrev_b32 v229, 16, v43
    v_perm_b32 v232, v27, v31, s97
    v_perm_b32 v233, v31, v35, s97
    v_perm_b32 v234, v19, v23, s97
    v_perm_b32 v235, v23, v27, s97
    v_and_b32 v236, 0xffff0000, v39
    v_and_b32 v237, 0xffff0000, v43
    v_dot2_f32_bf16 v230, v224, v56, 0
    v_dot2_f32_bf16 v231, v225, v56, 0
    v_dot2_f32_bf16 v230, v226, v57, v230
    v_dot2_f32_bf16 v231, v227, v57, v231
    v_dot2_f32_bf16 v238, v232, v58, 0
    buffer_load_dwordx4 v248, s[12:15], s92 offen offset:2048 lds
    v_dot2_f32_bf16 v239, v233, v58, 0
    v_dot2_f32_bf16 v238, v234, v59, v238
    v_dot2_f32_bf16 v239, v235, v59, v239
    v_mul_f32 v230, v230, v228
    v_mul_f32 v231, v231, v229
    v_mul_f32 v238, v238, v236
    v_mul_f32 v239, v239, v237
    v_cvt_pk_bf16_f32 v98, v231, v230
    v_cvt_pk_bf16_f32 v99, v239, v238
    ds_write_b32 v155, v92 offset:0
    ds_write_b32 v155, v93 offset:128
    ds_write_b32 v155, v94 offset:256
    ds_write_b32 v155, v95 offset:384
    ds_write_b32 v155, v96 offset:512
    ds_write_b32 v155, v97 offset:640
    ds_write_b32 v155, v98 offset:768
    ds_write_b32 v155, v99 offset:896
    s_waitcnt vmcnt(13) lgkmcnt(0)
    s_barrier
    ds_read_b128 v[16:19], v156
    ds_read_b128 v[20:23], v157 offset:1024
    ds_read_b128 v[60:63], v104 offset:0
    ds_read_b64_tr_b16 v[68:69], v112 offset:0
    ds_read_b64_tr_b16 v[70:71], v112 offset:512
    ds_read_b128 v[64:67], v104 offset:4096
    ds_read_b64_tr_b16 v[72:73], v113 offset:0
    ds_read_b64_tr_b16 v[74:75], v113 offset:512
    v_mov_b32 v3, 0
    buffer_load_dwordx2 v[8:9], v3, s[44:47], 0 offen sc1
    ds_read_b128 v[76:79], v105 offset:0
    ds_read_b64_tr_b16 v[84:85], v112 offset:6144
    ds_read_b64_tr_b16 v[86:87], v112 offset:6656
    ds_read_b128 v[80:83], v105 offset:4096
    ds_read_b64_tr_b16 v[88:89], v113 offset:6144
    ds_read_b64_tr_b16 v[90:91], v113 offset:6656
    s_waitcnt lgkmcnt(6)
    v_mfma_f32_32x32x16_bf16 v[160:175], v[68:71], v[60:63], 0
    v_mfma_f32_32x32x16_bf16 v[176:191], v[68:71], v[64:67], 0
    s_add_u32 m0, s82, 65536
    s_add_u32 s93, s80, 256
    buffer_load_dwordx4 v100, s[8:11], s93 offen lds
    v_mfma_f32_32x32x16_bf16 v[192:207], v[60:63], v[72:75], 0
    v_mfma_f32_32x32x16_bf16 v[208:223], v[64:67], v[72:75], 0
    buffer_load_dwordx4 v101, s[8:11], s93 offen offset:1024 lds
    ds_read_b128 v[60:63], v106 offset:0
    ds_read_b64_tr_b16 v[68:69], v112 offset:12288
    ds_read_b64_tr_b16 v[70:71], v112 offset:12800
    ds_read_b128 v[64:67], v106 offset:4096
    ds_read_b64_tr_b16 v[72:73], v113 offset:12288
    ds_read_b64_tr_b16 v[74:75], v113 offset:12800
    s_waitcnt lgkmcnt(6)
    v_mfma_f32_32x32x16_bf16 v[160:175], v[84:87], v[76:79], v[160:175]
    v_mfma_f32_32x32x16_bf16 v[176:191], v[84:87], v[80:83], v[176:191]
    s_add_u32 m0, s98, 65536
    s_add_u32 s92, s81, 393216
    buffer_load_dwordx4 v102, s[12:15], s92 offen lds
    v_mfma_f32_32x32x16_bf16 v[192:207], v[76:79], v[88:91], v[192:207]
    v_mfma_f32_32x32x16_bf16 v[208:223], v[80:83], v[88:91], v[208:223]
    buffer_load_dwordx4 v103, s[12:15], s92 offen offset:1024 lds
    ds_read_b128 v[76:79], v107 offset:0
    ds_read_b64_tr_b16 v[84:85], v112 offset:18432
    ds_read_b64_tr_b16 v[86:87], v112 offset:18944
    ds_read_b128 v[80:83], v107 offset:4096
    ds_read_b64_tr_b16 v[88:89], v113 offset:18432
    ds_read_b64_tr_b16 v[90:91], v113 offset:18944
    s_waitcnt lgkmcnt(6)
    v_mfma_f32_32x32x16_bf16 v[160:175], v[68:71], v[60:63], v[160:175]
    v_mfma_f32_32x32x16_bf16 v[176:191], v[68:71], v[64:67], v[176:191]
    buffer_load_dwordx4 v102, s[12:15], s92 offen offset:2048 lds
    s_add_u32 m0, s98, 68608
    v_mfma_f32_32x32x16_bf16 v[192:207], v[60:63], v[72:75], v[192:207]
    v_mfma_f32_32x32x16_bf16 v[208:223], v[64:67], v[72:75], v[208:223]
    s_nop 0
    buffer_load_dwordx4 v248, s[12:15], s92 offen lds
    buffer_load_dwordx4 v249, s[12:15], s92 offen offset:1024 lds
    buffer_load_dwordx4 v248, s[12:15], s92 offen offset:2048 lds
    buffer_store_dwordx4 v[16:19], v158, s[40:43], 0 offen sc1
    buffer_store_dwordx4 v[20:23], v159, s[40:43], 0 offen sc1
    s_waitcnt vmcnt(11) lgkmcnt(0)
    s_barrier
    ds_read_b128 v[60:63], v104 offset:32768
    ds_read_b64_tr_b16 v[68:69], v112 offset:32768
    ds_read_b64_tr_b16 v[70:71], v112 offset:33280
    ds_read_b128 v[64:67], v104 offset:36864
    ds_read_b64_tr_b16 v[72:73], v113 offset:32768
    ds_read_b64_tr_b16 v[74:75], v113 offset:33280
    v_mfma_f32_32x32x16_bf16 v[160:175], v[84:87], v[76:79], v[160:175]
    v_mfma_f32_32x32x16_bf16 v[176:191], v[84:87], v[80:83], v[176:191]
    s_add_u32 m0, s82, 0
    s_add_u32 s93, s80, 384
    buffer_load_dwordx4 v100, s[8:11], s93 offen lds
    v_mfma_f32_32x32x16_bf16 v[192:207], v[76:79], v[88:91], v[192:207]
    v_mfma_f32_32x32x16_bf16 v[208:223], v[80:83], v[88:91], v[208:223]
    buffer_load_dwordx4 v101, s[8:11], s93 offen offset:1024 lds
    ds_read_b128 v[76:79], v105 offset:32768
    ds_read_b64_tr_b16 v[84:85], v112 offset:38912
    ds_read_b64_tr_b16 v[86:87], v112 offset:39424
    ds_read_b128 v[80:83], v105 offset:36864
    ds_read_b64_tr_b16 v[88:89], v113 offset:38912
    ds_read_b64_tr_b16 v[90:91], v113 offset:39424
    s_waitcnt lgkmcnt(6)
    v_mfma_f32_32x32x16_bf16 v[160:175], v[68:71], v[60:63], v[160:175]
    v_mfma_f32_32x32x16_bf16 v[176:191], v[68:71], v[64:67], v[176:191]
    s_add_u32 m0, s98, 0
    s_add_u32 s92, s81, 589824
    buffer_load_dwordx4 v102, s[12:15], s92 offen lds
    v_mfma_f32_32x32x16_bf16 v[192:207], v[60:63], v[72:75], v[192:207]
    v_mfma_f32_32x32x16_bf16 v[208:223], v[64:67], v[72:75], v[208:223]
    buffer_load_dwordx4 v103, s[12:15], s92 offen offset:1024 lds
    ds_read_b128 v[60:63], v106 offset:32768
    ds_read_b64_tr_b16 v[68:69], v112 offset:45056
    ds_read_b64_tr_b16 v[70:71], v112 offset:45568
    ds_read_b128 v[64:67], v106 offset:36864
    ds_read_b64_tr_b16 v[72:73], v113 offset:45056
    ds_read_b64_tr_b16 v[74:75], v113 offset:45568
    s_waitcnt lgkmcnt(6)
    v_mfma_f32_32x32x16_bf16 v[160:175], v[84:87], v[76:79], v[160:175]
    v_mfma_f32_32x32x16_bf16 v[176:191], v[84:87], v[80:83], v[176:191]
    buffer_load_dwordx4 v102, s[12:15], s92 offen offset:2048 lds
    s_add_u32 m0, s98, 3072
    v_mfma_f32_32x32x16_bf16 v[192:207], v[76:79], v[88:91], v[192:207]
    v_mfma_f32_32x32x16_bf16 v[208:223], v[80:83], v[88:91], v[208:223]
    buffer_load_dwordx4 v248, s[12:15], s92 offen lds
    ds_read_b128 v[76:79], v107 offset:32768
    ds_read_b64_tr_b16 v[84:85], v112 offset:51200
    ds_read_b64_tr_b16 v[86:87], v112 offset:51712
    ds_read_b128 v[80:83], v107 offset:36864
    ds_read_b64_tr_b16 v[88:89], v113 offset:51200
    ds_read_b64_tr_b16 v[90:91], v113 offset:51712
    s_waitcnt lgkmcnt(6)
    v_mfma_f32_32x32x16_bf16 v[160:175], v[68:71], v[60:63], v[160:175]
    v_mfma_f32_32x32x16_bf16 v[176:191], v[68:71], v[64:67], v[176:191]
    buffer_load_dwordx4 v249, s[12:15], s92 offen offset:1024 lds
    v_mfma_f32_32x32x16_bf16 v[192:207], v[60:63], v[72:75], v[192:207]
    v_mfma_f32_32x32x16_bf16 v[208:223], v[64:67], v[72:75], v[208:223]
    buffer_load_dwordx4 v248, s[12:15], s92 offen offset:2048 lds
    s_waitcnt vmcnt(10) lgkmcnt(0)
    s_barrier
    ds_read_b128 v[60:63], v108 offset:0
    ds_read_b64_tr_b16 v[68:69], v114 offset:0
    ds_read_b64_tr_b16 v[70:71], v114 offset:512
    ds_read_b128 v[64:67], v108 offset:4096
    ds_read_b64_tr_b16 v[72:73], v115 offset:0
    ds_read_b64_tr_b16 v[74:75], v115 offset:512
    v_mfma_f32_32x32x16_bf16 v[160:175], v[84:87], v[76:79], v[160:175]
    v_mfma_f32_32x32x16_bf16 v[176:191], v[84:87], v[80:83], v[176:191]
    s_add_u32 m0, s82, 32768
    s_add_u32 s93, s80, 512
    buffer_load_dwordx4 v100, s[8:11], s93 offen lds
    v_mfma_f32_32x32x16_bf16 v[192:207], v[76:79], v[88:91], v[192:207]
    v_mfma_f32_32x32x16_bf16 v[208:223], v[80:83], v[88:91], v[208:223]
    buffer_load_dwordx4 v101, s[8:11], s93 offen offset:1024 lds
    ds_read_b128 v[76:79], v109 offset:0
    ds_read_b64_tr_b16 v[84:85], v114 offset:6144
    ds_read_b64_tr_b16 v[86:87], v114 offset:6656
    ds_read_b128 v[80:83], v109 offset:4096
    ds_read_b64_tr_b16 v[88:89], v115 offset:6144
    ds_read_b64_tr_b16 v[90:91], v115 offset:6656
    s_waitcnt lgkmcnt(6)
    v_mfma_f32_32x32x16_bf16 v[160:175], v[68:71], v[60:63], v[160:175]
    v_mfma_f32_32x32x16_bf16 v[176:191], v[68:71], v[64:67], v[176:191]
    s_add_u32 m0, s98, 32768
    s_add_u32 s92, s81, 786432
    buffer_load_dwordx4 v102, s[12:15], s92 offen lds
    v_mfma_f32_32x32x16_bf16 v[192:207], v[60:63], v[72:75], v[192:207]
    v_mfma_f32_32x32x16_bf16 v[208:223], v[64:67], v[72:75], v[208:223]
    buffer_load_dwordx4 v103, s[12:15], s92 offen offset:1024 lds
    ds_read_b128 v[60:63], v110 offset:0
    ds_read_b64_tr_b16 v[68:69], v114 offset:12288
    ds_read_b64_tr_b16 v[70:71], v114 offset:12800
    ds_read_b128 v[64:67], v110 offset:4096
    ds_read_b64_tr_b16 v[72:73], v115 offset:12288
    ds_read_b64_tr_b16 v[74:75], v115 offset:12800
    s_waitcnt lgkmcnt(6)
    v_mfma_f32_32x32x16_bf16 v[160:175], v[84:87], v[76:79], v[160:175]
    v_mfma_f32_32x32x16_bf16 v[176:191], v[84:87], v[80:83], v[176:191]
    buffer_load_dwordx4 v102, s[12:15], s92 offen offset:2048 lds
    s_add_u32 m0, s98, 35840
    v_mfma_f32_32x32x16_bf16 v[192:207], v[76:79], v[88:91], v[192:207]
    v_mfma_f32_32x32x16_bf16 v[208:223], v[80:83], v[88:91], v[208:223]
    buffer_load_dwordx4 v248, s[12:15], s92 offen lds
    ds_read_b128 v[76:79], v111 offset:0
    ds_read_b64_tr_b16 v[84:85], v114 offset:18432
    ds_read_b64_tr_b16 v[86:87], v114 offset:18944
    ds_read_b128 v[80:83], v111 offset:4096
    ds_read_b64_tr_b16 v[88:89], v115 offset:18432
    ds_read_b64_tr_b16 v[90:91], v115 offset:18944
    s_waitcnt lgkmcnt(6)
    v_mfma_f32_32x32x16_bf16 v[160:175], v[68:71], v[60:63], v[160:175]
    v_mfma_f32_32x32x16_bf16 v[176:191], v[68:71], v[64:67], v[176:191]
    buffer_load_dwordx4 v249, s[12:15], s92 offen offset:1024 lds
    v_mfma_f32_32x32x16_bf16 v[192:207], v[60:63], v[72:75], v[192:207]
    v_mfma_f32_32x32x16_bf16 v[208:223], v[64:67], v[72:75], v[208:223]
    buffer_load_dwordx4 v248, s[12:15], s92 offen offset:2048 lds
    s_waitcnt vmcnt(8) lgkmcnt(0)
    s_barrier
    v_readfirstlane_b32 s52, v8
    v_readfirstlane_b32 s53, v9
    s_nop 0
    s_cmp_eq_u32 s53, 0
    s_cbranch_scc1 L_nonce_poll_3
L_nonce_ok_2:
    buffer_store_dwordx2 v[8:9], v10, s[40:43], s16 offen sc1
    ds_read_b128 v[60:63], v104 offset:0
    ds_read_b64_tr_b16 v[68:69], v112 offset:0
    ds_read_b64_tr_b16 v[70:71], v112 offset:512
    ds_read_b128 v[64:67], v104 offset:4096
    ds_read_b64_tr_b16 v[72:73], v113 offset:0
    ds_read_b64_tr_b16 v[74:75], v113 offset:512
    v_mfma_f32_32x32x16_bf16 v[160:175], v[84:87], v[76:79], v[160:175]
    v_mfma_f32_32x32x16_bf16 v[176:191], v[84:87], v[80:83], v[176:191]
    s_add_u32 m0, s82, 65536
    s_add_u32 s93, s80, 640
    buffer_load_dwordx4 v100, s[8:11], s93 offen lds
    v_mfma_f32_32x32x16_bf16 v[192:207], v[76:79], v[88:91], v[192:207]
    v_mfma_f32_32x32x16_bf16 v[208:223], v[80:83], v[88:91], v[208:223]
    buffer_load_dwordx4 v101, s[8:11], s93 offen offset:1024 lds
    ds_read_b128 v[76:79], v105 offset:0
    ds_read_b64_tr_b16 v[84:85], v112 offset:6144
    ds_read_b64_tr_b16 v[86:87], v112 offset:6656
    ds_read_b128 v[80:83], v105 offset:4096
    ds_read_b64_tr_b16 v[88:89], v113 offset:6144
    ds_read_b64_tr_b16 v[90:91], v113 offset:6656
    s_waitcnt lgkmcnt(6)
    v_mfma_f32_32x32x16_bf16 v[160:175], v[68:71], v[60:63], v[160:175]
    v_mfma_f32_32x32x16_bf16 v[176:191], v[68:71], v[64:67], v[176:191]
    s_add_u32 m0, s98, 65536
    s_add_u32 s92, s81, 983040
    buffer_load_dwordx4 v102, s[12:15], s92 offen lds
    v_mfma_f32_32x32x16_bf16 v[192:207], v[60:63], v[72:75], v[192:207]
    v_mfma_f32_32x32x16_bf16 v[208:223], v[64:67], v[72:75], v[208:223]
    buffer_load_dwordx4 v103, s[12:15], s92 offen offset:1024 lds
    ds_read_b128 v[60:63], v106 offset:0
    ds_read_b64_tr_b16 v[68:69], v112 offset:12288
    ds_read_b64_tr_b16 v[70:71], v112 offset:12800
    ds_read_b128 v[64:67], v106 offset:4096
    ds_read_b64_tr_b16 v[72:73], v113 offset:12288
    ds_read_b64_tr_b16 v[74:75], v113 offset:12800
    s_waitcnt lgkmcnt(6)
    v_mfma_f32_32x32x16_bf16 v[160:175], v[84:87], v[76:79], v[160:175]
    v_mfma_f32_32x32x16_bf16 v[176:191], v[84:87], v[80:83], v[176:191]
    buffer_load_dwordx4 v102, s[12:15], s92 offen offset:2048 lds
    s_add_u32 m0, s98, 68608
    v_mfma_f32_32x32x16_bf16 v[192:207], v[76:79], v[88:91], v[192:207]
    v_mfma_f32_32x32x16_bf16 v[208:223], v[80:83], v[88:91], v[208:223]
    buffer_load_dwordx4 v248, s[12:15], s92 offen lds
    ds_read_b128 v[76:79], v107 offset:0
    ds_read_b64_tr_b16 v[84:85], v112 offset:18432
    ds_read_b64_tr_b16 v[86:87], v112 offset:18944
    ds_read_b128 v[80:83], v107 offset:4096
    ds_read_b64_tr_b16 v[88:89], v113 offset:18432
    ds_read_b64_tr_b16 v[90:91], v113 offset:18944
    s_waitcnt lgkmcnt(6)
    v_mfma_f32_32x32x16_bf16 v[160:175], v[68:71], v[60:63], v[160:175]
    v_mfma_f32_32x32x16_bf16 v[176:191], v[68:71], v[64:67], v[176:191]
    buffer_load_dwordx4 v249, s[12:15], s92 offen offset:1024 lds
    v_mfma_f32_32x32x16_bf16 v[192:207], v[60:63], v[72:75], v[192:207]
    v_mfma_f32_32x32x16_bf16 v[208:223], v[64:67], v[72:75], v[208:223]
    buffer_load_dwordx4 v248, s[12:15], s92 offen offset:2048 lds
    s_waitcnt vmcnt(9) lgkmcnt(0)
    s_barrier
    ds_read_b128 v[60:63], v104 offset:32768
    ds_read_b64_tr_b16 v[68:69], v112 offset:32768
    ds_read_b64_tr_b16 v[70:71], v112 offset:33280
    ds_read_b128 v[64:67], v104 offset:36864
    ds_read_b64_tr_b16 v[72:73], v113 offset:32768
    ds_read_b64_tr_b16 v[74:75], v113 offset:33280
    v_mfma_f32_32x32x16_bf16 v[160:175], v[84:87], v[76:79], v[160:175]
    v_mfma_f32_32x32x16_bf16 v[176:191], v[84:87], v[80:83], v[176:191]
    buffer_load_dwordx4 v[116:119], v136, s[28:31], 0 offen nt
    s_add_u32 m0, s82, 0
    s_add_u32 s93, s80, 768
    buffer_load_dwordx4 v100, s[8:11], s93 offen lds
    v_mfma_f32_32x32x16_bf16 v[192:207], v[76:79], v[88:91], v[192:207]
    v_mfma_f32_32x32x16_bf16 v[208:223], v[80:83], v[88:91], v[208:223]
    buffer_load_dwordx4 v[120:123], v137, s[28:31], 0 offen nt
    buffer_load_dwordx4 v101, s[8:11], s93 offen offset:1024 lds
    ds_read_b128 v[76:79], v105 offset:32768
    ds_read_b64_tr_b16 v[84:85], v112 offset:38912
    ds_read_b64_tr_b16 v[86:87], v112 offset:39424
    ds_read_b128 v[80:83], v105 offset:36864
    ds_read_b64_tr_b16 v[88:89], v113 offset:38912
    ds_read_b64_tr_b16 v[90:91], v113 offset:39424
    s_waitcnt lgkmcnt(6)
    v_mfma_f32_32x32x16_bf16 v[160:175], v[68:71], v[60:63], v[160:175]
    v_mfma_f32_32x32x16_bf16 v[176:191], v[68:71], v[64:67], v[176:191]
    buffer_load_dwordx2 v[124:125], v138, s[28:31], 0 offen nt
    s_add_u32 m0, s98, 0
    s_add_u32 s92, s81, 1179648
    buffer_load_dwordx4 v102, s[12:15], s92 offen lds
    v_mfma_f32_32x32x16_bf16 v[192:207], v[60:63], v[72:75], v[192:207]
    v_mfma_f32_32x32x16_bf16 v[208:223], v[64:67], v[72:75], v[208:223]
    buffer_load_dwordx4 v103, s[12:15], s92 offen offset:1024 lds
    ds_read_b128 v[60:63], v106 offset:32768
    ds_read_b64_tr_b16 v[68:69], v112 offset:45056
    ds_read_b64_tr_b16 v[70:71], v112 offset:45568
    ds_read_b128 v[64:67], v106 offset:36864
    ds_read_b64_tr_b16 v[72:73], v113 offset:45056
    ds_read_b64_tr_b16 v[74:75], v113 offset:45568
    s_waitcnt lgkmcnt(6)
    v_mfma_f32_32x32x16_bf16 v[160:175], v[84:87], v[76:79], v[160:175]
    v_mfma_f32_32x32x16_bf16 v[176:191], v[84:87], v[80:83], v[176:191]
    buffer_load_dwordx4 v102, s[12:15], s92 offen offset:2048 lds
    s_add_u32 m0, s98, 3072
    v_mfma_f32_32x32x16_bf16 v[192:207], v[76:79], v[88:91], v[192:207]
    v_mfma_f32_32x32x16_bf16 v[208:223], v[80:83], v[88:91], v[208:223]
    buffer_load_dwordx4 v248, s[12:15], s92 offen lds
    ds_read_b128 v[76:79], v107 offset:32768
    ds_read_b64_tr_b16 v[84:85], v112 offset:51200
    ds_read_b64_tr_b16 v[86:87], v112 offset:51712
    ds_read_b128 v[80:83], v107 offset:36864
    ds_read_b64_tr_b16 v[88:89], v113 offset:51200
    ds_read_b64_tr_b16 v[90:91], v113 offset:51712
    s_waitcnt lgkmcnt(6)
    v_mfma_f32_32x32x16_bf16 v[160:175], v[68:71], v[60:63], v[160:175]
    v_mfma_f32_32x32x16_bf16 v[176:191], v[68:71], v[64:67], v[176:191]
    buffer_load_dwordx4 v249, s[12:15], s92 offen offset:1024 lds
    v_mfma_f32_32x32x16_bf16 v[192:207], v[60:63], v[72:75], v[192:207]
    v_mfma_f32_32x32x16_bf16 v[208:223], v[64:67], v[72:75], v[208:223]
    buffer_load_dwordx4 v248, s[12:15], s92 offen offset:2048 lds
    s_waitcnt vmcnt(11) lgkmcnt(0)
    s_barrier
    ds_read_b128 v[60:63], v108 offset:0
    ds_read_b64_tr_b16 v[68:69], v114 offset:0
    ds_read_b64_tr_b16 v[70:71], v114 offset:512
    ds_read_b128 v[64:67], v108 offset:4096
    ds_read_b64_tr_b16 v[72:73], v115 offset:0
    ds_read_b64_tr_b16 v[74:75], v115 offset:512
    v_mfma_f32_32x32x16_bf16 v[160:175], v[84:87], v[76:79], v[160:175]
    v_mfma_f32_32x32x16_bf16 v[176:191], v[84:87], v[80:83], v[176:191]
    s_add_u32 m0, s82, 32768
    s_add_u32 s93, s80, 896
    buffer_load_dwordx4 v100, s[8:11], s93 offen lds
    v_mfma_f32_32x32x16_bf16 v[192:207], v[76:79], v[88:91], v[192:207]
    v_mfma_f32_32x32x16_bf16 v[208:223], v[80:83], v[88:91], v[208:223]
    buffer_load_dwordx4 v101, s[8:11], s93 offen offset:1024 lds
    ds_read_b128 v[76:79], v109 offset:0
    ds_read_b64_tr_b16 v[84:85], v114 offset:6144
    ds_read_b64_tr_b16 v[86:87], v114 offset:6656
    ds_read_b128 v[80:83], v109 offset:4096
    ds_read_b64_tr_b16 v[88:89], v115 offset:6144
    ds_read_b64_tr_b16 v[90:91], v115 offset:6656
    s_waitcnt lgkmcnt(6)
    v_mfma_f32_32x32x16_bf16 v[160:175], v[68:71], v[60:63], v[160:175]
    v_mfma_f32_32x32x16_bf16 v[176:191], v[68:71], v[64:67], v[176:191]
    s_add_u32 m0, s98, 32768
    s_add_u32 s92, s81, 1376256
    buffer_load_dwordx4 v102, s[12:15], s92 offen lds
    v_mfma_f32_32x32x16_bf16 v[192:207], v[60:63], v[72:75], v[192:207]
    v_mfma_f32_32x32x16_bf16 v[208:223], v[64:67], v[72:75], v[208:223]
    buffer_load_dwordx4 v103, s[12:15], s92 offen offset:1024 lds
    ds_read_b128 v[60:63], v110 offset:0
    ds_read_b64_tr_b16 v[68:69], v114 offset:12288
    ds_read_b64_tr_b16 v[70:71], v114 offset:12800
    ds_read_b128 v[64:67], v110 offset:4096
    ds_read_b64_tr_b16 v[72:73], v115 offset:12288
    ds_read_b64_tr_b16 v[74:75], v115 offset:12800
    s_waitcnt lgkmcnt(6)
    v_mfma_f32_32x32x16_bf16 v[160:175], v[84:87], v[76:79], v[160:175]
    v_mfma_f32_32x32x16_bf16 v[176:191], v[84:87], v[80:83], v[176:191]
    buffer_load_dwordx4 v102, s[12:15], s92 offen offset:2048 lds
    s_add_u32 m0, s98, 35840
    v_mfma_f32_32x32x16_bf16 v[192:207], v[76:79], v[88:91], v[192:207]
    v_mfma_f32_32x32x16_bf16 v[208:223], v[80:83], v[88:91], v[208:223]
    buffer_load_dwordx4 v248, s[12:15], s92 offen lds
    ds_read_b128 v[76:79], v111 offset:0
    ds_read_b64_tr_b16 v[84:85], v114 offset:18432
    ds_read_b64_tr_b16 v[86:87], v114 offset:18944
    ds_read_b128 v[80:83], v111 offset:4096
    ds_read_b64_tr_b16 v[88:89], v115 offset:18432
    ds_read_b64_tr_b16 v[90:91], v115 offset:18944
    s_waitcnt lgkmcnt(6)
    v_mfma_f32_32x32x16_bf16 v[160:175], v[68:71], v[60:63], v[160:175]
    v_mfma_f32_32x32x16_bf16 v[176:191], v[68:71], v[64:67], v[176:191]
    buffer_load_dwordx4 v249, s[12:15], s92 offen offset:1024 lds
    v_mfma_f32_32x32x16_bf16 v[192:207], v[60:63], v[72:75], v[192:207]
    v_mfma_f32_32x32x16_bf16 v[208:223], v[64:67], v[72:75], v[208:223]
    buffer_load_dwordx4 v248, s[12:15], s92 offen offset:2048 lds
    s_waitcnt vmcnt(8) lgkmcnt(0)
    s_barrier
    ds_read_b128 v[60:63], v104 offset:0
    ds_read_b64_tr_b16 v[68:69], v112 offset:0
    ds_read_b64_tr_b16 v[70:71], v112 offset:512
    ds_read_b128 v[64:67], v104 offset:4096
    ds_read_b64_tr_b16 v[72:73], v113 offset:0
    ds_read_b64_tr_b16 v[74:75], v113 offset:512
    v_mfma_f32_32x32x16_bf16 v[160:175], v[84:87], v[76:79], v[160:175]
    v_alignbit_b32 v136, v117, v116, 16
    v_alignbit_b32 v137, v118, v117, 16
    v_alignbit_b32 v138, v119, v118, 16
    v_alignbit_b32 v139, v120, v119, 16
    v_alignbit_b32 v140, v121, v120, 16
    v_alignbit_b32 v141, v122, v121, 16
    v_mfma_f32_32x32x16_bf16 v[176:191], v[84:87], v[80:83], v[176:191]
    buffer_load_dwordx2 v[4:5], v7, s[40:43], s20 offen sc1
    v_alignbit_b32 v142, v123, v122, 16
    v_alignbit_b32 v143, v124, v123, 16
    v_mov_b32 v24, v117
    v_mov_b32 v25, v118
    v_mov_b32 v26, v119
    v_mov_b32 v27, v120
    v_mfma_f32_32x32x16_bf16 v[192:207], v[76:79], v[88:91], v[192:207]
    v_mov_b32 v28, v121
    v_mov_b32 v29, v122
    v_mov_b32 v30, v123
    v_mov_b32 v31, v124
    v_alignbit_b32 v92, v118, v117, 16
    v_alignbit_b32 v93, v119, v118, 16
    v_mfma_f32_32x32x16_bf16 v[208:223], v[80:83], v[88:91], v[208:223]
    s_getpc_b64 s[88:89]
L_tabpc:
    s_add_u32 s88, s88, (L_masktab - L_tabpc)
    s_addc_u32 s89, s89, 0
    s_mov_b32 s90, 6144
    s_mov_b32 s91, 0x20000
    buffer_load_dwordx4 v[144:147], v13, s[88:91], 0 offen
    buffer_load_dwordx4 v[148:151], v13, s[88:91], 0 offen offset:1024
    v_alignbit_b32 v94, v120, v119, 16
    v_alignbit_b32 v95, v121, v120, 16
    v_alignbit_b32 v96, v122, v121, 16
    v_alignbit_b32 v97, v123, v122, 16
    v_alignbit_b32 v98, v124, v123, 16
    v_alignbit_b32 v99, v125, v124, 16
    ds_read_b128 v[76:79], v105 offset:0
    ds_read_b64_tr_b16 v[84:85], v112 offset:6144
    ds_read_b64_tr_b16 v[86:87], v112 offset:6656
    ds_read_b128 v[80:83], v105 offset:4096
    ds_read_b64_tr_b16 v[88:89], v113 offset:6144
    ds_read_b64_tr_b16 v[90:91], v113 offset:6656
    s_waitcnt lgkmcnt(6)
    v_mfma_f32_32x32x16_bf16 v[160:175], v[68:71], v[60:63], v[160:175]
    v_mfma_f32_32x32x16_bf16 v[176:191], v[68:71], v[64:67], v[176:191]
    buffer_load_dwordx4 v[152:155], v13, s[88:91], 0 offen offset:2048
    buffer_load_dwordx4 v[156:159], v13, s[88:91], 0 offen offset:3072
    v_mfma_f32_32x32x16_bf16 v[192:207], v[60:63], v[72:75], v[192:207]
    v_mfma_f32_32x32x16_bf16 v[208:223], v[64:67], v[72:75], v[208:223]
    ds_read_b128 v[60:63], v106 offset:0
    ds_read_b64_tr_b16 v[68:69], v112 offset:12288
    ds_read_b64_tr_b16 v[70:71], v112 offset:12800
    ds_read_b128 v[64:67], v106 offset:4096
    ds_read_b64_tr_b16 v[72:73], v113 offset:12288
    ds_read_b64_tr_b16 v[74:75], v113 offset:12800
    ds_write_b128 v132, v[116:119]
    ds_write_b128 v132, v[120:123] offset:16
    s_waitcnt lgkmcnt(8)
    v_mfma_f32_32x32x16_bf16 v[160:175], v[84:87], v[76:79], v[160:175]
    v_mfma_f32_32x32x16_bf16 v[176:191], v[84:87], v[80:83], v[176:191]
    v_mfma_f32_32x32x16_bf16 v[192:207], v[76:79], v[88:91], v[192:207]
    v_mfma_f32_32x32x16_bf16 v[208:223], v[80:83], v[88:91], v[208:223]
    ds_read_b128 v[76:79], v107 offset:0
    ds_read_b64_tr_b16 v[84:85], v112 offset:18432
    ds_read_b64_tr_b16 v[86:87], v112 offset:18944
    ds_read_b128 v[80:83], v107 offset:4096
    ds_read_b64_tr_b16 v[88:89], v113 offset:18432
    ds_read_b64_tr_b16 v[90:91], v113 offset:18944
    ds_write_b128 v132, v[136:139] offset:4160
    ds_write_b128 v132, v[140:143] offset:4176
    s_waitcnt lgkmcnt(8)
    v_mfma_f32_32x32x16_bf16 v[160:175], v[68:71], v[60:63], v[160:175]
    v_mfma_f32_32x32x16_bf16 v[176:191], v[68:71], v[64:67], v[176:191]
    v_mfma_f32_32x32x16_bf16 v[192:207], v[60:63], v[72:75], v[192:207]
    v_mfma_f32_32x32x16_bf16 v[208:223], v[64:67], v[72:75], v[208:223]
    s_waitcnt vmcnt(5) lgkmcnt(0)
    s_barrier
    s_waitcnt vmcnt(4)
    v_cmp_ne_u64 vcc, s[52:53], v[4:5]
    s_nop 0
    s_and_b32 vcc_lo, vcc_lo, -1
    s_cselect_b32 s64, 1, 0
    buffer_load_dwordx4 v[16:19], v13, s[40:43], s67 offen sc1
    buffer_load_dwordx4 v[20:23], v13, s[40:43], s67 offen offset:2048 sc1
    ds_read_b128 v[60:63], v104 offset:32768
    ds_read_b64_tr_b16 v[68:69], v112 offset:32768
    ds_read_b64_tr_b16 v[70:71], v112 offset:33280
    ds_read_b128 v[64:67], v104 offset:36864
    ds_read_b64_tr_b16 v[72:73], v113 offset:32768
    ds_read_b64_tr_b16 v[74:75], v113 offset:33280
    v_mfma_f32_32x32x16_bf16 v[160:175], v[84:87], v[76:79], v[160:175]
    v_mfma_f32_32x32x16_bf16 v[176:191], v[84:87], v[80:83], v[176:191]
    buffer_store_dwordx4 v[128:131], v12, s[40:43], s99 offen sc1
    v_mfma_f32_32x32x16_bf16 v[192:207], v[76:79], v[88:91], v[192:207]
    v_mfma_f32_32x32x16_bf16 v[208:223], v[80:83], v[88:91], v[208:223]
    s_add_u32 s86, s99, 32768
    buffer_store_dwordx4 v[128:131], v12, s[40:43], s86 offen sc1
    ds_read_b128 v[76:79], v105 offset:32768
    ds_read_b64_tr_b16 v[84:85], v112 offset:38912
    ds_read_b64_tr_b16 v[86:87], v112 offset:39424
    ds_read_b128 v[80:83], v105 offset:36864
    ds_read_b64_tr_b16 v[88:89], v113 offset:38912
    ds_read_b64_tr_b16 v[90:91], v113 offset:39424
    ds_write_b128 v132, v[24:27] offset:8320
    ds_write_b128 v132, v[28:31] offset:8336
    s_waitcnt lgkmcnt(8)
    v_mfma_f32_32x32x16_bf16 v[160:175], v[68:71], v[60:63], v[160:175]
    v_mfma_f32_32x32x16_bf16 v[176:191], v[68:71], v[64:67], v[176:191]
    v_mfma_f32_32x32x16_bf16 v[192:207], v[60:63], v[72:75], v[192:207]
    v_mfma_f32_32x32x16_bf16 v[208:223], v[64:67], v[72:75], v[208:223]
    ds_read_b128 v[60:63], v106 offset:32768
    ds_read_b64_tr_b16 v[68:69], v112 offset:45056
    ds_read_b64_tr_b16 v[70:71], v112 offset:45568
    ds_read_b128 v[64:67], v106 offset:36864
    ds_read_b64_tr_b16 v[72:73], v113 offset:45056
    ds_read_b64_tr_b16 v[74:75], v113 offset:45568
    ds_write_b128 v132, v[92:95] offset:12480
    ds_write_b128 v132, v[96:99] offset:12496
    s_waitcnt lgkmcnt(8)
    v_mfma_f32_32x32x16_bf16 v[160:175], v[84:87], v[76:79], v[160:175]
    v_mfma_f32_32x32x16_bf16 v[176:191], v[84:87], v[80:83], v[176:191]
    v_mfma_f32_32x32x16_bf16 v[192:207], v[76:79], v[88:91], v[192:207]
    v_mfma_f32_32x32x16_bf16 v[208:223], v[80:83], v[88:91], v[208:223]
    ds_read_b128 v[76:79], v107 offset:32768
    ds_read_b64_tr_b16 v[84:85], v112 offset:51200
    ds_read_b64_tr_b16 v[86:87], v112 offset:51712
    ds_read_b128 v[80:83], v107 offset:36864
    ds_read_b64_tr_b16 v[88:89], v113 offset:51200
    ds_read_b64_tr_b16 v[90:91], v113 offset:51712
    s_waitcnt lgkmcnt(6)
    v_mfma_f32_32x32x16_bf16 v[160:175], v[68:71], v[60:63], v[160:175]
    v_mfma_f32_32x32x16_bf16 v[176:191], v[68:71], v[64:67], v[176:191]
    v_mfma_f32_32x32x16_bf16 v[192:207], v[60:63], v[72:75], v[192:207]
    v_mfma_f32_32x32x16_bf16 v[208:223], v[64:67], v[72:75], v[208:223]
    s_waitcnt lgkmcnt(0)
    v_mfma_f32_32x32x16_bf16 v[160:175], v[84:87], v[76:79], v[160:175]
    v_mfma_f32_32x32x16_bf16 v[176:191], v[84:87], v[80:83], v[176:191]
    v_mfma_f32_32x32x16_bf16 v[192:207], v[76:79], v[88:91], v[192:207]
    v_mfma_f32_32x32x16_bf16 v[208:223], v[80:83], v[88:91], v[208:223]
    s_waitcnt vmcnt(4)
    s_nop 7
    s_nop 1
    s_add_u32 s85, s56, 2304
    v_cvt_pk_bf16_f32 v232, v168, v169
    v_cvt_pk_bf16_f32 v233, v170, v171
    v_cvt_pk_bf16_f32 v234, v172, v173
    v_cvt_pk_bf16_f32 v235, v174, v175
    v_cvt_pk_bf16_f32 v236, v184, v185
    v_cvt_pk_bf16_f32 v237, v186, v187
    v_cvt_pk_bf16_f32 v238, v188, v189
    v_cvt_pk_bf16_f32 v239, v190, v191
    buffer_store_dwordx4 v[232:235], v13, s[40:43], s56 offen sc1
    v_cvt_pk_bf16_f32 v240, v192, v193
    v_cvt_pk_bf16_f32 v241, v194, v195
    v_cvt_pk_bf16_f32 v242, v196, v197
    v_cvt_pk_bf16_f32 v243, v198, v199
    v_cvt_pk_bf16_f32 v244, v200, v201
    v_cvt_pk_bf16_f32 v245, v202, v203
    v_cvt_pk_bf16_f32 v246, v204, v205
    v_cvt_pk_bf16_f32 v247, v206, v207
    buffer_store_dwordx4 v[236:239], v13, s[40:43], s85 offen sc1
    v_cvt_pk_bf16_f32 v248, v208, v209
    v_cvt_pk_bf16_f32 v249, v210, v211
    v_cvt_pk_bf16_f32 v250, v212, v213
    v_cvt_pk_bf16_f32 v251, v214, v215
    v_cvt_pk_bf16_f32 v252, v216, v217
    v_cvt_pk_bf16_f32 v253, v218, v219
    v_cvt_pk_bf16_f32 v254, v220, v221
    v_cvt_pk_bf16_f32 v255, v222, v223
    s_mov_b32 exec_lo, 0x10000
    s_mov_b32 exec_hi, 0x10000
    v_mov_b32 v240, 0x3f803f80
    v_mov_b32 v241, 0x3f803f80
    v_mov_b32 v242, 0x3f803f80
    v_mov_b32 v243, 0x3f803f80
    v_mov_b32 v244, 0x3f803f80
    v_mov_b32 v245, 0x3f803f80
    v_mov_b32 v246, 0x3f803f80
    v_mov_b32 v247, 0x3f803f80
    s_mov_b64 exec, -1
    s_nop 0
    buffer_store_dwordx4 v[240:243], v11, s[40:43], s56 offen offset:1024 sc1
    buffer_store_dwordx4 v[244:247], v11, s[40:43], s56 offen offset:1664 sc1
    s_mov_b32 exec_lo, 0x10000
    s_mov_b32 exec_hi, 0x10000
    v_mov_b32 v248, 0x3f803f80
    v_mov_b32 v249, 0x3f803f80
    v_mov_b32 v250, 0x3f803f80
    v_mov_b32 v251, 0x3f803f80
    v_mov_b32 v252, 0x3f803f80
    v_mov_b32 v253, 0x3f803f80
    v_mov_b32 v254, 0x3f803f80
    v_mov_b32 v255, 0x3f803f80
    s_mov_b64 exec, -1
    s_nop 0
    buffer_store_dwordx4 v[248:251], v11, s[40:43], s85 offen offset:1024 sc1
    buffer_store_dwordx4 v[252:255], v11, s[40:43], s85 offen offset:1664 sc1
    s_mov_b32 s87, 4096
    buffer_load_dwordx4 v[200:203], v13, s[88:91], s87 offen
    buffer_load_dwordx4 v[204:207], v13, s[88:91], s87 offen offset:1024
    s_waitcnt vmcnt(10)
    s_cmp_lg_u32 s64, 0
    s_cbranch_scc1 L_u_slow_4
L_u_back_5:
    ds_write_b128 v127, v[16:19]
    ds_write_b128 v127, v[20:23] offset:2048
    s_waitcnt lgkmcnt(0)
    s_barrier
    ds_read_b128 v[48:51], v15 offset:3584
    ds_read_b64 v[16:17], v14 offset:0
    ds_read_b64 v[18:19], v14 offset:8
    ds_read_b128 v[52:55], v15 offset:3072
    ds_read_b64 v[20:21], v14 offset:512
    ds_read_b64 v[22:23], v14 offset:520
    ds_read_b128 v[56:59], v15 offset:2560
    ds_read_b64 v[24:25], v14 offset:1024
    ds_read_b64 v[26:27], v14 offset:1032
    ds_read_b128 v[60:63], v15 offset:2048
    ds_read_b64 v[28:29], v14 offset:1536
    ds_read_b64 v[30:31], v14 offset:1544
    ds_read_b128 v[64:67], v15 offset:1536
    ds_read_b64 v[32:33], v14 offset:2048
    ds_read_b64 v[34:35], v14 offset:2056
    ds_read_b128 v[68:71], v15 offset:1024
    ds_read_b64 v[36:37], v14 offset:2560
    ds_read_b64 v[38:39], v14 offset:2568
    ds_read_b128 v[72:75], v15 offset:512
    ds_read_b64 v[40:41], v14 offset:3072
    ds_read_b64 v[42:43], v14 offset:3080
    ds_read_b128 v[76:79], v15 offset:0
    ds_read_b64 v[44:45], v14 offset:3584
    ds_read_b64 v[46:47], v14 offset:3592
    s_waitcnt lgkmcnt(0)
    v_mfma_f32_16x16x32_bf16 a[96:99], v[16:19], v[48:51], 0
    ds_read_b128 v[112:115], v15 offset:3648
    s_mov_b32 s86, 0x3eb8aa3b
    v_mfma_f32_16x16x32_bf16 a[100:103], v[16:19], v[52:55], 0
    ds_read_b64 v[80:81], v14 offset:64
    v_mul_f32 v160, s86, v160
    v_mfma_f32_16x16x32_bf16 a[104:107], v[16:19], v[56:59], 0
    ds_read_b64 v[82:83], v14 offset:72
    v_mul_f32 v161, s86, v161
    v_mfma_f32_16x16x32_bf16 a[108:111], v[16:19], v[60:63], 0
    ds_read_b128 v[116:119], v15 offset:3136
    v_mul_f32 v162, s86, v162
    v_mfma_f32_16x16x32_bf16 a[112:115], v[16:19], v[64:67], 0
    ds_read_b64 v[84:85], v14 offset:576
    v_mul_f32 v163, s86, v163
    v_mfma_f32_16x16x32_bf16 a[116:119], v[16:19], v[68:71], 0
    ds_read_b64 v[86:87], v14 offset:584
    v_mul_f32 v164, s86, v164
    v_mfma_f32_16x16x32_bf16 a[120:123], v[16:19], v[72:75], 0
    ds_read_b128 v[120:123], v15 offset:2624
    v_mul_f32 v165, s86, v165
    v_mfma_f32_16x16x32_bf16 a[124:127], v[16:19], v[76:79], 0
    ds_read_b64 v[88:89], v14 offset:1088
    v_mul_f32 v166, s86, v166
    v_mfma_f32_16x16x32_bf16 a[100:103], v[20:23], v[48:51], a[100:103]
    ds_read_b64 v[90:91], v14 offset:1096
    v_mul_f32 v167, s86, v167
    v_mfma_f32_16x16x32_bf16 a[104:107], v[20:23], v[52:55], a[104:107]
    ds_read_b128 v[124:127], v15 offset:2112
    v_cvt_pk_bf16_f32 v224, v160, v161
    v_mfma_f32_16x16x32_bf16 a[108:111], v[20:23], v[56:59], a[108:111]
    ds_read_b64 v[92:93], v14 offset:1600
    v_cvt_pk_bf16_f32 v225, v162, v163
    v_mfma_f32_16x16x32_bf16 a[112:115], v[20:23], v[60:63], a[112:115]
    ds_read_b64 v[94:95], v14 offset:1608
    v_cvt_pk_bf16_f32 v226, v164, v165
    v_mfma_f32_16x16x32_bf16 a[116:119], v[20:23], v[64:67], a[116:119]
    ds_read_b128 v[128:131], v15 offset:1600
    v_cvt_pk_bf16_f32 v227, v166, v167
    v_mfma_f32_16x16x32_bf16 a[120:123], v[20:23], v[68:71], a[120:123]
    ds_read_b64 v[96:97], v14 offset:2112
    v_mul_f32 v176, s86, v176
    v_mfma_f32_16x16x32_bf16 a[124:127], v[20:23], v[72:75], a[124:127]
    ds_read_b64 v[98:99], v14 offset:2120
    v_mul_f32 v177, s86, v177
    v_mfma_f32_16x16x32_bf16 a[104:107], v[24:27], v[48:51], a[104:107]
    ds_read_b128 v[132:135], v15 offset:1088
    v_mul_f32 v178, s86, v178
    v_mfma_f32_16x16x32_bf16 a[108:111], v[24:27], v[52:55], a[108:111]
    ds_read_b64 v[100:101], v14 offset:2624
    v_mul_f32 v179, s86, v179
    v_mfma_f32_16x16x32_bf16 a[112:115], v[24:27], v[56:59], a[112:115]
    ds_read_b64 v[102:103], v14 offset:2632
    v_mul_f32 v180, s86, v180
    v_mfma_f32_16x16x32_bf16 a[116:119], v[24:27], v[60:63], a[116:119]
    ds_read_b128 v[136:139], v15 offset:576
    v_mul_f32 v181, s86, v181
    v_mfma_f32_16x16x32_bf16 a[120:123], v[24:27], v[64:67], a[120:123]
    ds_read_b64 v[104:105], v14 offset:3136
    v_mul_f32 v182, s86, v182
    v_mfma_f32_16x16x32_bf16 a[124:127], v[24:27], v[68:71], a[124:127]
    ds_read_b64 v[106:107], v14 offset:3144
    v_mul_f32 v183, s86, v183
    v_mfma_f32_16x16x32_bf16 a[108:111], v[28:31], v[48:51], a[108:111]
    ds_read_b128 v[140:143], v15 offset:64
    v_cvt_pk_bf16_f32 v228, v176, v177
    v_mfma_f32_16x16x32_bf16 a[112:115], v[28:31], v[52:55], a[112:115]
    ds_read_b64 v[108:109], v14 offset:3648
    v_cvt_pk_bf16_f32 v229, v178, v179
    v_mfma_f32_16x16x32_bf16 a[116:119], v[28:31], v[56:59], a[116:119]
    ds_read_b64 v[110:111], v14 offset:3656
    v_cvt_pk_bf16_f32 v230, v180, v181
    v_mfma_f32_16x16x32_bf16 a[120:123], v[28:31], v[60:63], a[120:123]
    v_cvt_pk_bf16_f32 v231, v182, v183
    v_lshrrev_b32 v2, 4, v1
    v_mfma_f32_16x16x32_bf16 a[124:127], v[28:31], v[64:67], a[124:127]
    v_and_b32 v3, 7, v1
    v_lshrrev_b32 v6, 1, v3
    v_mfma_f32_16x16x32_bf16 a[112:115], v[32:35], v[48:51], a[112:115]
    v_xor_b32 v6, v6, v2
    v_lshlrev_b32 v6, 5, v6
    v_mfma_f32_16x16x32_bf16 a[116:119], v[32:35], v[52:55], a[116:119]
    v_and_b32 v3, 1, v3
    v_lshl_add_u32 v6, v3, 4, v6
    v_mfma_f32_16x16x32_bf16 a[120:123], v[32:35], v[56:59], a[120:123]
    v_lshrrev_b32 v3, 3, v1
    v_lshl_add_u32 v176, v3, 10, v6
    v_mfma_f32_16x16x32_bf16 a[124:127], v[32:35], v[60:63], a[124:127]
    v_add_u32 v177, 7168, v176
    v_add_u32 v178, 14336, v176
    v_mfma_f32_16x16x32_bf16 a[116:119], v[36:39], v[48:51], a[116:119]
    v_add_u32 v179, 21504, v176
    v_mfma_f32_32x32x16_bf16 v[208:223], v[232:235], v[224:227], v[144:159]
    v_mfma_f32_16x16x32_bf16 a[120:123], v[36:39], v[52:55], a[120:123]
    s_add_u32 m0, s66, 0
    s_add_u32 s93, s63, 0
    buffer_load_dwordx4 v176, s[32:35], s93 offen offset:0 lds
    v_mfma_f32_16x16x32_bf16 a[124:127], v[36:39], v[56:59], a[124:127]
    v_mfma_f32_16x16x32_bf16 a[120:123], v[40:43], v[48:51], a[120:123]
    v_mfma_f32_16x16x32_bf16 a[124:127], v[40:43], v[52:55], a[124:127]
    v_mfma_f32_16x16x32_bf16 a[124:127], v[44:47], v[48:51], a[124:127]
    s_waitcnt lgkmcnt(0)
    v_mfma_f32_16x16x32_bf16 a[96:99], v[80:83], v[112:115], a[96:99]
    ds_read_b128 v[48:51], v15 offset:3712
    buffer_load_dwordx4 v177, s[32:35], s93 offen offset:1024 lds
    v_mfma_f32_16x16x32_bf16 a[100:103], v[80:83], v[116:119], a[100:103]
    ds_read_b64 v[16:17], v14 offset:128
    v_max3_f32 v2, v208, v209, v210
    v_mfma_f32_16x16x32_bf16 a[104:107], v[80:83], v[120:123], a[104:107]
    ds_read_b64 v[18:19], v14 offset:136
    v_max3_f32 v2, v2, v211, v212
    v_mfma_f32_16x16x32_bf16 a[108:111], v[80:83], v[124:127], a[108:111]
    ds_read_b128 v[52:55], v15 offset:3200
    v_max3_f32 v2, v2, v213, v214
    v_mfma_f32_16x16x32_bf16 a[112:115], v[80:83], v[128:131], a[112:115]
    ds_read_b64 v[20:21], v14 offset:640
    v_max3_f32 v2, v2, v215, v216
    v_mfma_f32_16x16x32_bf16 a[116:119], v[80:83], v[132:135], a[116:119]
    ds_read_b64 v[22:23], v14 offset:648
    v_max3_f32 v2, v2, v217, v218
    buffer_load_dwordx4 v178, s[32:35], s93 offen offset:2048 lds
    v_mfma_f32_16x16x32_bf16 a[120:123], v[80:83], v[136:139], a[120:123]
    ds_read_b128 v[56:59], v15 offset:2688
    v_max3_f32 v2, v2, v219, v220
    v_mfma_f32_16x16x32_bf16 a[124:127], v[80:83], v[140:143], a[124:127]
    ds_read_b64 v[24:25], v14 offset:1152
    v_max3_f32 v2, v2, v221, v222
    v_mfma_f32_16x16x32_bf16 a[100:103], v[84:87], v[112:115], a[100:103]
    ds_read_b64 v[26:27], v14 offset:1160
    v_max_f32 v2, v2, v223
    v_mfma_f32_16x16x32_bf16 a[104:107], v[84:87], v[116:119], a[104:107]
    ds_read_b128 v[60:63], v15 offset:2176
    v_mfma_f32_32x32x16_bf16 v[208:223], v[232:235], v[228:231], 0
    v_mfma_f32_16x16x32_bf16 a[108:111], v[84:87], v[120:123], a[108:111]
    ds_read_b64 v[28:29], v14 offset:1664
    s_mov_b32 s86, 0x42800000
    buffer_load_dwordx4 v179, s[32:35], s93 offen offset:3072 lds
    v_mfma_f32_16x16x32_bf16 a[112:115], v[84:87], v[124:127], a[112:115]
    ds_read_b64 v[30:31], v14 offset:1672
    v_mov_b32 v3, v2
    s_nop 1
    v_permlane32_swap_b32 v2, v3
    s_nop 1
    v_max_f32 v2, v2, v3
    v_mfma_f32_16x16x32_bf16 a[116:119], v[84:87], v[128:131], a[116:119]
    ds_read_b128 v[64:67], v15 offset:1664
    v_add_f32 v2, s86, v2
    v_mfma_f32_16x16x32_bf16 a[120:123], v[84:87], v[132:135], a[120:123]
    ds_read_b64 v[32:33], v14 offset:2176
    v_sub_f32 v2, 0, v2
    v_mfma_f32_16x16x32_bf16 a[124:127], v[84:87], v[136:139], a[124:127]
    ds_read_b64 v[34:35], v14 offset:2184
    v_mov_b32 v184, v2
    s_waitcnt vmcnt(6)
    buffer_store_dwordx2 v[8:9], v10, s[40:43], s17 offen sc1
    buffer_store_dwordx2 v[8:9], v10, s[40:43], s18 offen sc1
    v_mfma_f32_16x16x32_bf16 a[104:107], v[88:91], v[112:115], a[104:107]
    ds_read_b128 v[68:71], v15 offset:1152
    v_mov_b32 v185, v2
    s_add_u32 m0, s66, 4096
    s_add_u32 s93, s63, 32768
    buffer_load_dwordx4 v176, s[32:35], s93 offen offset:0 lds
    v_mfma_f32_16x16x32_bf16 a[108:111], v[88:91], v[116:119], a[108:111]
    ds_read_b64 v[36:37], v14 offset:2688
    v_mov_b32 v186, v2
    v_mfma_f32_16x16x32_bf16 a[112:115], v[88:91], v[120:123], a[112:115]
    ds_read_b64 v[38:39], v14 offset:2696
    v_mov_b32 v187, v2
    v_mfma_f32_16x16x32_bf16 a[116:119], v[88:91], v[124:127], a[116:119]
    ds_read_b128 v[72:75], v15 offset:640
    v_mov_b32 v188, v2
    v_mfma_f32_16x16x32_bf16 a[120:123], v[88:91], v[128:131], a[120:123]
    ds_read_b64 v[40:41], v14 offset:3200
    v_mov_b32 v189, v2
    v_mfma_f32_16x16x32_bf16 a[124:127], v[88:91], v[132:135], a[124:127]
    ds_read_b64 v[42:43], v14 offset:3208
    v_mov_b32 v190, v2
    buffer_load_dwordx4 v177, s[32:35], s93 offen offset:1024 lds
    v_mfma_f32_16x16x32_bf16 a[108:111], v[92:95], v[112:115], a[108:111]
    ds_read_b128 v[76:79], v15 offset:128
    v_mov_b32 v191, v2
    v_mfma_f32_16x16x32_bf16 a[112:115], v[92:95], v[116:119], a[112:115]
    ds_read_b64 v[44:45], v14 offset:3712
    v_mov_b32 v192, v2
    v_mfma_f32_16x16x32_bf16 a[116:119], v[92:95], v[120:123], a[116:119]
    ds_read_b64 v[46:47], v14 offset:3720
    v_mov_b32 v193, v2
    v_mfma_f32_16x16x32_bf16 a[120:123], v[92:95], v[124:127], a[120:123]
    v_mov_b32 v194, v2
    v_mov_b32 v195, v2
    v_mfma_f32_16x16x32_bf16 a[124:127], v[92:95], v[128:131], a[124:127]
    v_mov_b32 v196, v2
    v_mov_b32 v197, v2
    buffer_load_dwordx4 v178, s[32:35], s93 offen offset:2048 lds
    v_mfma_f32_16x16x32_bf16 a[112:115], v[96:99], v[112:115], a[112:115]
    v_mov_b32 v198, v2
    v_mov_b32 v199, v2
    v_mfma_f32_16x16x32_bf16 a[116:119], v[96:99], v[116:119], a[116:119]
    v_max3_f32 v2, v208, v209, v210
    v_max3_f32 v2, v2, v211, v212
    v_mfma_f32_16x16x32_bf16 a[120:123], v[96:99], v[120:123], a[120:123]
    v_max3_f32 v2, v2, v213, v214
    v_max3_f32 v2, v2, v215, v216
    v_mfma_f32_16x16x32_bf16 a[124:127], v[96:99], v[124:127], a[124:127]
    v_max3_f32 v2, v2, v217, v218
    v_max3_f32 v2, v2, v219, v220
    v_mfma_f32_16x16x32_bf16 a[116:119], v[100:103], v[112:115], a[116:119]
    v_max3_f32 v2, v2, v221, v222
    v_max_f32 v2, v2, v223
    buffer_load_dwordx4 v179, s[32:35], s93 offen offset:3072 lds
    v_mfma_f32_16x16x32_bf16 a[120:123], v[100:103], v[116:119], a[120:123]
    v_mfma_f32_32x32x16_bf16 v[208:223], v[236:239], v[228:231], v[144:159]
    v_mfma_f32_16x16x32_bf16 a[124:127], v[100:103], v[120:123], a[124:127]
    v_mfma_f32_16x16x32_bf16 a[120:123], v[104:107], v[112:115], a[120:123]
    v_mfma_f32_16x16x32_bf16 a[124:127], v[104:107], v[116:119], a[124:127]
    v_mfma_f32_16x16x32_bf16 a[124:127], v[108:111], v[112:115], a[124:127]
    s_add_u32 m0, s66, 8192
    s_add_u32 s93, s63, 65536
    buffer_load_dwordx4 v176, s[32:35], s93 offen offset:0 lds
    s_waitcnt lgkmcnt(0)
    v_mfma_f32_16x16x32_bf16 a[96:99], v[16:19], v[48:51], a[96:99]
    ds_read_b128 v[112:115], v15 offset:3776
    v_mfma_f32_16x16x32_bf16 a[100:103], v[16:19], v[52:55], a[100:103]
    ds_read_b64 v[80:81], v14 offset:192
    v_mfma_f32_16x16x32_bf16 a[104:107], v[16:19], v[56:59], a[104:107]
    ds_read_b64 v[82:83], v14 offset:200
    v_max3_f32 v2, v2, v208, v209
    v_mfma_f32_16x16x32_bf16 a[108:111], v[16:19], v[60:63], a[108:111]
    ds_read_b128 v[116:119], v15 offset:3264
    v_max3_f32 v2, v2, v210, v211
    v_mfma_f32_16x16x32_bf16 a[112:115], v[16:19], v[64:67], a[112:115]
    ds_read_b64 v[84:85], v14 offset:704
    v_max3_f32 v2, v2, v212, v213
    buffer_load_dwordx4 v177, s[32:35], s93 offen offset:1024 lds
    v_mfma_f32_16x16x32_bf16 a[116:119], v[16:19], v[68:71], a[116:119]
    ds_read_b64 v[86:87], v14 offset:712
    v_max3_f32 v2, v2, v214, v215
    v_mfma_f32_16x16x32_bf16 a[120:123], v[16:19], v[72:75], a[120:123]
    ds_read_b128 v[120:123], v15 offset:2752
    v_max3_f32 v2, v2, v216, v217
    v_mfma_f32_16x16x32_bf16 a[124:127], v[16:19], v[76:79], a[124:127]
    ds_read_b64 v[88:89], v14 offset:1216
    v_max3_f32 v2, v2, v218, v219
    v_mfma_f32_16x16x32_bf16 a[100:103], v[20:23], v[48:51], a[100:103]
    ds_read_b64 v[90:91], v14 offset:1224
    v_max3_f32 v2, v2, v220, v221
    v_mfma_f32_16x16x32_bf16 a[104:107], v[20:23], v[52:55], a[104:107]
    ds_read_b128 v[124:127], v15 offset:2240
    v_max3_f32 v2, v2, v222, v223
    buffer_load_dwordx4 v178, s[32:35], s93 offen offset:2048 lds
    v_mfma_f32_16x16x32_bf16 a[108:111], v[20:23], v[56:59], a[108:111]
    ds_read_b64 v[92:93], v14 offset:1728
    v_mov_b32 v3, v2
    s_nop 1
    v_permlane32_swap_b32 v2, v3
    s_nop 1
    v_max_f32 v2, v2, v3
    v_mfma_f32_16x16x32_bf16 a[112:115], v[20:23], v[60:63], a[112:115]
    ds_read_b64 v[94:95], v14 offset:1736
    v_add_f32 v2, s86, v2
    v_mfma_f32_16x16x32_bf16 a[116:119], v[20:23], v[64:67], a[116:119]
    ds_read_b128 v[128:131], v15 offset:1728
    v_sub_f32 v2, 0, v2
    v_mfma_f32_16x16x32_bf16 a[120:123], v[20:23], v[68:71], a[120:123]
    ds_read_b64 v[96:97], v14 offset:2240
    v_mov_b32 v160, v2
    v_mfma_f32_16x16x32_bf16 a[124:127], v[20:23], v[72:75], a[124:127]
    ds_read_b64 v[98:99], v14 offset:2248
    v_mov_b32 v161, v2
    buffer_load_dwordx4 v179, s[32:35], s93 offen offset:3072 lds
    v_mfma_f32_16x16x32_bf16 a[104:107], v[24:27], v[48:51], a[104:107]
    ds_read_b128 v[132:135], v15 offset:1216
    v_mov_b32 v162, v2
    v_mfma_f32_16x16x32_bf16 a[108:111], v[24:27], v[52:55], a[108:111]
    ds_read_b64 v[100:101], v14 offset:2752
    v_mov_b32 v163, v2
    v_mfma_f32_16x16x32_bf16 a[112:115], v[24:27], v[56:59], a[112:115]
    ds_read_b64 v[102:103], v14 offset:2760
    v_mov_b32 v164, v2
    v_mfma_f32_16x16x32_bf16 a[116:119], v[24:27], v[60:63], a[116:119]
    ds_read_b128 v[136:139], v15 offset:704
    v_mov_b32 v165, v2
    v_mfma_f32_16x16x32_bf16 a[120:123], v[24:27], v[64:67], a[120:123]
    ds_read_b64 v[104:105], v14 offset:3264
    v_mov_b32 v166, v2
    s_add_u32 m0, s66, 12288
    s_add_u32 s93, s63, 98304
    buffer_load_dwordx4 v176, s[32:35], s93 offen offset:0 lds
    v_mfma_f32_16x16x32_bf16 a[124:127], v[24:27], v[68:71], a[124:127]
    ds_read_b64 v[106:107], v14 offset:3272
    v_mov_b32 v167, v2
    v_mfma_f32_16x16x32_bf16 a[108:111], v[28:31], v[48:51], a[108:111]
    ds_read_b128 v[140:143], v15 offset:192
    v_mov_b32 v168, v2
    v_mfma_f32_16x16x32_bf16 a[112:115], v[28:31], v[52:55], a[112:115]
    ds_read_b64 v[108:109], v14 offset:3776
    v_mov_b32 v169, v2
    v_mfma_f32_16x16x32_bf16 a[116:119], v[28:31], v[56:59], a[116:119]
    ds_read_b64 v[110:111], v14 offset:3784
    v_mov_b32 v170, v2
    v_mfma_f32_16x16x32_bf16 a[120:123], v[28:31], v[60:63], a[120:123]
    v_mov_b32 v171, v2
    v_mov_b32 v172, v2
    buffer_load_dwordx4 v177, s[32:35], s93 offen offset:1024 lds
    v_mfma_f32_16x16x32_bf16 a[124:127], v[28:31], v[64:67], a[124:127]
    v_mov_b32 v173, v2
    v_mov_b32 v174, v2
    v_mfma_f32_16x16x32_bf16 a[112:115], v[32:35], v[48:51], a[112:115]
    v_mov_b32 v175, v2
    v_mfma_f32_16x16x32_bf16 a[116:119], v[32:35], v[52:55], a[116:119]
    v_mfma_f32_16x16x32_bf16 a[120:123], v[32:35], v[56:59], a[120:123]
    v_mfma_f32_16x16x32_bf16 a[124:127], v[32:35], v[60:63], a[124:127]
    buffer_load_dwordx4 v178, s[32:35], s93 offen offset:2048 lds
    v_mfma_f32_16x16x32_bf16 a[116:119], v[36:39], v[48:51], a[116:119]
    v_mfma_f32_16x16x32_bf16 a[120:123], v[36:39], v[52:55], a[120:123]
    v_mfma_f32_16x16x32_bf16 a[124:127], v[36:39], v[56:59], a[124:127]
    v_mfma_f32_16x16x32_bf16 a[120:123], v[40:43], v[48:51], a[120:123]
    v_mfma_f32_16x16x32_bf16 a[124:127], v[40:43], v[52:55], a[124:127]
    buffer_load_dwordx4 v179, s[32:35], s93 offen offset:3072 lds
    v_mfma_f32_16x16x32_bf16 a[124:127], v[44:47], v[48:51], a[124:127]
    s_waitcnt lgkmcnt(0)
    v_mfma_f32_16x16x32_bf16 a[96:99], v[80:83], v[112:115], a[96:99]
    v_mfma_f32_16x16x32_bf16 a[100:103], v[80:83], v[116:119], a[100:103]
    v_mfma_f32_16x16x32_bf16 a[104:107], v[80:83], v[120:123], a[104:107]
    buffer_load_dwordx2 v[4:5], v7, s[40:43], s21 offen sc1
    v_mfma_f32_16x16x32_bf16 a[108:111], v[80:83], v[124:127], a[108:111]
    v_mfma_f32_16x16x32_bf16 a[112:115], v[80:83], v[128:131], a[112:115]
    v_mfma_f32_16x16x32_bf16 a[116:119], v[80:83], v[132:135], a[116:119]
    v_mfma_f32_16x16x32_bf16 a[120:123], v[80:83], v[136:139], a[120:123]
    v_mfma_f32_16x16x32_bf16 a[124:127], v[80:83], v[140:143], a[124:127]
    v_mfma_f32_16x16x32_bf16 a[100:103], v[84:87], v[112:115], a[100:103]
    v_mfma_f32_16x16x32_bf16 a[104:107], v[84:87], v[116:119], a[104:107]
    v_mfma_f32_16x16x32_bf16 a[108:111], v[84:87], v[120:123], a[108:111]
    v_mfma_f32_16x16x32_bf16 a[112:115], v[84:87], v[124:127], a[112:115]
    v_mfma_f32_16x16x32_bf16 a[116:119], v[84:87], v[128:131], a[116:119]
    v_mfma_f32_16x16x32_bf16 a[120:123], v[84:87], v[132:135], a[120:123]
    v_mfma_f32_16x16x32_bf16 a[124:127], v[84:87], v[136:139], a[124:127]
    v_mfma_f32_16x16x32_bf16 a[104:107], v[88:91], v[112:115], a[104:107]
    v_mfma_f32_16x16x32_bf16 a[108:111], v[88:91], v[116:119], a[108:111]
    v_mfma_f32_16x16x32_bf16 a[112:115], v[88:91], v[120:123], a[112:115]
    v_mfma_f32_16x16x32_bf16 a[116:119], v[88:91], v[124:127], a[116:119]
    v_mfma_f32_16x16x32_bf16 a[120:123], v[88:91], v[128:131], a[120:123]
    v_mfma_f32_16x16x32_bf16 a[124:127], v[88:91], v[132:135], a[124:127]
    v_mfma_f32_16x16x32_bf16 a[108:111], v[92:95], v[112:115], a[108:111]
    v_mfma_f32_16x16x32_bf16 a[112:115], v[92:95], v[116:119], a[112:115]
    v_mfma_f32_16x16x32_bf16 a[116:119], v[92:95], v[120:123], a[116:119]
    v_mfma_f32_16x16x32_bf16 a[120:123], v[92:95], v[124:127], a[120:123]
    v_mfma_f32_16x16x32_bf16 a[124:127], v[92:95], v[128:131], a[124:127]
    v_mfma_f32_16x16x32_bf16 a[112:115], v[96:99], v[112:115], a[112:115]
    v_mfma_f32_16x16x32_bf16 a[116:119], v[96:99], v[116:119], a[116:119]
    v_mfma_f32_16x16x32_bf16 a[120:123], v[96:99], v[120:123], a[120:123]
    v_mfma_f32_16x16x32_bf16 a[124:127], v[96:99], v[124:127], a[124:127]
    v_mfma_f32_16x16x32_bf16 a[116:119], v[100:103], v[112:115], a[116:119]
    v_mfma_f32_16x16x32_bf16 a[120:123], v[100:103], v[116:119], a[120:123]
    v_mfma_f32_16x16x32_bf16 a[124:127], v[100:103], v[120:123], a[124:127]
    v_mfma_f32_16x16x32_bf16 a[120:123], v[104:107], v[112:115], a[120:123]
    v_mfma_f32_16x16x32_bf16 a[124:127], v[104:107], v[116:119], a[124:127]
    v_mfma_f32_16x16x32_bf16 a[124:127], v[108:111], v[112:115], a[124:127]
    s_waitcnt vmcnt(0)
    s_mov_b32 s55, 0
    s_branch L_f2_chk_11
L_f2_9:
    s_sleep 2
    buffer_load_dwordx2 v[4:5], v7, s[40:43], s21 offen sc1
    s_waitcnt vmcnt(0)
L_f2_chk_11:
    s_add_u32 s55, s55, 1
    v_cmp_ne_u64 vcc, s[52:53], v[4:5]
    s_nop 0
    s_and_b32 vcc_lo, vcc_lo, s68
    s_cbranch_scc0 L_f2_done_10
    s_cmp_lt_u32 s55, 0x20000
    s_cbranch_scc1 L_f2_9
L_f2_done_10:
    s_sub_u32 s90, s56, 2304
    buffer_load_dwordx4 a[28:31], v13, s[40:43], s90 offen sc1
    buffer_load_dwordx4 a[88:91], v11, s[40:43], s90 offen offset:1024 sc1
    buffer_load_dwordx4 a[92:95], v11, s[40:43], s90 offen offset:1664 sc1
    s_sub_u32 s90, s56, 4608
    buffer_load_dwordx4 a[24:27], v13, s[40:43], s90 offen sc1
    buffer_load_dwordx4 a[80:83], v11, s[40:43], s90 offen offset:1024 sc1
    buffer_load_dwordx4 a[84:87], v11, s[40:43], s90 offen offset:1664 sc1
    s_lshl_b32 s84, s3, 12
    s_add_u32 s84, s84, 65536
    v_add_u32 v5, s84, v13
    v_xor_b32 v6, 0x1000, v5
    s_cmp_lg_u32 s71, 0
    s_cbranch_scc1 L_rho1_12
    ds_write_b128 v5, a[112:115] offset:0
    ds_write_b128 v5, a[116:119] offset:1024
    ds_write_b128 v5, a[120:123] offset:2048
    ds_write_b128 v5, a[124:127] offset:3072
    v_accvgpr_read_b32 v32, a96
    v_accvgpr_read_b32 v33, a97
    v_accvgpr_read_b32 v34, a98
    v_accvgpr_read_b32 v35, a99
    v_accvgpr_read_b32 v36, a100
    v_accvgpr_read_b32 v37, a101
    v_accvgpr_read_b32 v38, a102
    v_accvgpr_read_b32 v39, a103
    v_accvgpr_read_b32 v40, a104
    v_accvgpr_read_b32 v41, a105
    v_accvgpr_read_b32 v42, a106
    v_accvgpr_read_b32 v43, a107
    v_accvgpr_read_b32 v44, a108
    v_accvgpr_read_b32 v45, a109
    v_accvgpr_read_b32 v46, a110
    v_accvgpr_read_b32 v47, a111
    s_branch L_rhojoin_13
L_rho1_12:
    ds_write_b128 v5, a[96:99] offset:0
    ds_write_b128 v5, a[100:103] offset:1024
    ds_write_b128 v5, a[104:107] offset:2048
    ds_write_b128 v5, a[108:111] offset:3072
    v_accvgpr_read_b32 v32, a112
    v_accvgpr_read_b32 v33, a113
    v_accvgpr_read_b32 v34, a114
    v_accvgpr_read_b32 v35, a115
    v_accvgpr_read_b32 v36, a116
    v_accvgpr_read_b32 v37, a117
    v_accvgpr_read_b32 v38, a118
    v_accvgpr_read_b32 v39, a119
    v_accvgpr_read_b32 v40, a120
    v_accvgpr_read_b32 v41, a121
    v_accvgpr_read_b32 v42, a122
    v_accvgpr_read_b32 v43, a123
    v_accvgpr_read_b32 v44, a124
    v_accvgpr_read_b32 v45, a125
    v_accvgpr_read_b32 v46, a126
    v_accvgpr_read_b32 v47, a127
L_rhojoin_13:
    s_lshr_b32 s84, s3, 1
    s_mul_i32 s84, s84, 4608
    s_lshl_b32 s86, s71, 11
    s_sub_u32 s84, s84, s86
    s_add_u32 s84, s84, 134136
    v_and_b32 v2, 15, v1
    v_lshrrev_b32 v3, 4, v1
    v_lshlrev_b32 v2, 5, v2
    v_lshl_add_u32 v2, v3, 3, v2
    v_sub_u32 v3, s84, v2
    ds_read_b64 v[48:49], v3 offset:1536
    ds_read_b64 v[50:51], v3 offset:1024
    ds_read_b64 v[52:53], v3 offset:512
    ds_read_b64 v[54:55], v3 offset:0
    s_lshl_b32 s85, s3, 11
    s_add_u32 s85, s85, 140800
    v_add_u32 v2, s85, v2
    v_add_u32 v3, s85, v13
    s_waitcnt lgkmcnt(0)
    s_barrier
    s_sub_u32 s90, s56, 6912
    buffer_load_dwordx4 a[20:23], v13, s[40:43], s90 offen sc1
    ds_read_b128 v[16:19], v6 offset:0
    ds_read_b128 v[20:23], v6 offset:1024
    ds_read_b128 v[24:27], v6 offset:2048
    ds_read_b128 v[28:31], v6 offset:3072
    v_and_b32 v56, 0xffff0000, v49
    v_lshlrev_b32 v57, 16, v49
    v_and_b32 v58, 0xffff0000, v48
    v_lshlrev_b32 v59, 16, v48
    v_fmac_f32 v32, s69, v56
    v_fmac_f32 v33, s69, v57
    v_fmac_f32 v34, s69, v58
    v_fmac_f32 v35, s69, v59
    v_and_b32 v56, 0xffff0000, v51
    v_lshlrev_b32 v57, 16, v51
    buffer_load_dwordx4 a[72:75], v11, s[40:43], s90 offen offset:1024 sc1
    buffer_load_dwordx4 a[76:79], v11, s[40:43], s90 offen offset:1664 sc1
    v_and_b32 v58, 0xffff0000, v50
    v_lshlrev_b32 v59, 16, v50
    v_fmac_f32 v36, s69, v56
    v_fmac_f32 v37, s69, v57
    v_fmac_f32 v38, s69, v58
    v_fmac_f32 v39, s69, v59
    v_and_b32 v56, 0xffff0000, v53
    v_lshlrev_b32 v57, 16, v53
    v_and_b32 v58, 0xffff0000, v52
    v_lshlrev_b32 v59, 16, v52
    v_fmac_f32 v40, s69, v56
    v_fmac_f32 v41, s69, v57
    v_fmac_f32 v42, s69, v58
    v_fmac_f32 v43, s69, v59
    s_sub_u32 s90, s56, 9216
    buffer_load_dwordx4 a[16:19], v13, s[40:43], s90 offen sc1
    v_and_b32 v56, 0xffff0000, v55
    v_lshlrev_b32 v57, 16, v55
    v_and_b32 v58, 0xffff0000, v54
    v_lshlrev_b32 v59, 16, v54
    v_fmac_f32 v44, s69, v56
    v_fmac_f32 v45, s69, v57
    v_fmac_f32 v46, s69, v58
    v_fmac_f32 v47, s69, v59
    s_waitcnt lgkmcnt(0)
    v_add_f32 v32, v32, v16
    v_add_f32 v33, v33, v17
    v_add_f32 v34, v34, v18
    v_add_f32 v35, v35, v19
    v_cvt_pk_bf16_f32 v60, v32, v33
    buffer_load_dwordx4 a[64:67], v11, s[40:43], s90 offen offset:1024 sc1
    buffer_load_dwordx4 a[68:71], v11, s[40:43], s90 offen offset:1664 sc1
    v_cvt_pk_bf16_f32 v61, v34, v35
    ds_write_b64 v2, v[60:61] offset:0
    v_add_f32 v36, v36, v20
    v_add_f32 v37, v37, v21
    v_add_f32 v38, v38, v22
    v_add_f32 v39, v39, v23
    v_cvt_pk_bf16_f32 v62, v36, v37
    v_cvt_pk_bf16_f32 v63, v38, v39
    ds_write_b64 v2, v[62:63] offset:512
    v_add_f32 v40, v40, v24
    v_add_f32 v41, v41, v25
    v_add_f32 v42, v42, v26
    v_add_f32 v43, v43, v27
    v_cvt_pk_bf16_f32 v64, v40, v41
    v_cvt_pk_bf16_f32 v65, v42, v43
    ds_write_b64 v2, v[64:65] offset:1024
    v_add_f32 v44, v44, v28
    v_add_f32 v45, v45, v29
    v_add_f32 v46, v46, v30
    v_add_f32 v47, v47, v31
    v_cvt_pk_bf16_f32 v66, v44, v45
    v_cvt_pk_bf16_f32 v67, v46, v47
    ds_write_b64 v2, v[66:67] offset:1536
    s_waitcnt lgkmcnt(0)
    ds_read_b128 v[208:211], v3
    ds_read_b128 v[212:215], v3 offset:1024
    s_waitcnt lgkmcnt(0)
    buffer_store_dwordx4 v[208:211], v13, s[40:43], s57 offen sc1
    buffer_store_dwordx4 v[212:215], v13, s[40:43], s57 offen offset:1024 sc1
L_attn_main_14:
    v_mfma_f32_32x32x16_bf16 v[16:31], v[232:235], v[224:227], v[184:199]
    v_and_b32 v4, 15, v1
    v_lshrrev_b32 v5, 4, v1
    v_lshlrev_b32 v4, 10, v4
    v_lshl_add_u32 v222, v5, 5, v4
    v_mov_b32 v218, 0
    v_mov_b32 v219, 0
    v_mov_b32 v220, 0
    v_mov_b32 v221, 0
    v_lshrrev_b32 v4, 3, v1
    v_and_b32 v5, 7, v1
    v_lshlrev_b32 v223, 12, v4
    v_lshl_add_u32 v223, v5, 4, v223
    v_exp_f32 v16, v16
    v_exp_f32 v17, v17
    v_exp_f32 v18, v18
    v_exp_f32 v19, v19
    v_exp_f32 v20, v20
    s_sub_u32 s90, s56, 11520
    buffer_load_dwordx4 a[12:15], v13, s[40:43], s90 offen sc1
    v_exp_f32 v21, v21
    v_exp_f32 v22, v22
    v_exp_f32 v23, v23
    v_exp_f32 v24, v24
    v_mfma_f32_32x32x16_bf16 v[32:47], v[236:239], v[228:231], v[160:175]
    v_exp_f32 v25, v25
    v_exp_f32 v26, v26
    v_exp_f32 v27, v27
    v_exp_f32 v28, v28
    buffer_load_dwordx4 a[56:59], v11, s[40:43], s90 offen offset:1024 sc1
    buffer_load_dwordx4 a[60:63], v11, s[40:43], s90 offen offset:1664 sc1
    v_exp_f32 v29, v29
    v_exp_f32 v30, v30
    v_exp_f32 v31, v31
    v_cvt_pk_bf16_f32 v48, v16, v17
    v_cvt_pk_bf16_f32 v49, v18, v19
    v_cvt_pk_bf16_f32 v50, v20, v21
    v_cvt_pk_bf16_f32 v51, v22, v23
    v_cvt_pk_bf16_f32 v52, v24, v25
    v_cvt_pk_bf16_f32 v53, v26, v27
    v_cvt_pk_bf16_f32 v54, v28, v29
    v_cvt_pk_bf16_f32 v55, v30, v31
    v_and_b32 v48, v200, v48
    v_and_b32 v49, v201, v49
    v_and_b32 v50, v202, v50
    v_and_b32 v51, v203, v51
    v_and_b32 v52, v204, v52
    v_and_b32 v53, v205, v53
    v_and_b32 v54, v206, v54
    v_and_b32 v55, v207, v55
    v_exp_f32 v32, v32
    v_exp_f32 v33, v33
    v_mfma_f32_32x32x16_bf16 v[96:111], v[240:243], v[48:51], 0
    v_exp_f32 v34, v34
    v_exp_f32 v35, v35
    v_exp_f32 v36, v36
    v_mfma_f32_32x32x16_bf16 v[96:111], v[244:247], v[52:55], v[96:111]
    s_sub_u32 s90, s56, 13824
    buffer_load_dwordx4 a[8:11], v13, s[40:43], s90 offen sc1
    v_exp_f32 v37, v37
    v_exp_f32 v38, v38
    v_exp_f32 v39, v39
    v_exp_f32 v40, v40
    v_mfma_f32_32x32x16_bf16 v[16:31], v[232:235], v[228:231], v[160:175]
    v_exp_f32 v41, v41
    v_exp_f32 v42, v42
    v_exp_f32 v43, v43
    v_exp_f32 v44, v44
    buffer_load_dwordx4 a[48:51], v11, s[40:43], s90 offen offset:1024 sc1
    buffer_load_dwordx4 a[52:55], v11, s[40:43], s90 offen offset:1664 sc1
    v_exp_f32 v45, v45
    v_exp_f32 v46, v46
    v_exp_f32 v47, v47
    v_cvt_pk_bf16_f32 v56, v32, v33
    v_cvt_pk_bf16_f32 v57, v34, v35
    v_cvt_pk_bf16_f32 v58, v36, v37
    v_cvt_pk_bf16_f32 v59, v38, v39
    v_cvt_pk_bf16_f32 v60, v40, v41
    v_cvt_pk_bf16_f32 v61, v42, v43
    v_cvt_pk_bf16_f32 v62, v44, v45
    v_cvt_pk_bf16_f32 v63, v46, v47
    v_and_b32 v56, v200, v56
    v_and_b32 v57, v201, v57
    v_and_b32 v58, v202, v58
    v_and_b32 v59, v203, v59
    v_and_b32 v60, v204, v60
    v_and_b32 v61, v205, v61
    v_and_b32 v62, v206, v62
    v_and_b32 v63, v207, v63
    v_exp_f32 v16, v16
    v_exp_f32 v17, v17
    v_mfma_f32_32x32x16_bf16 v[112:127], v[248:251], v[56:59], 0
    v_exp_f32 v18, v18
    v_exp_f32 v19, v19
    v_exp_f32 v20, v20
    v_mfma_f32_32x32x16_bf16 v[112:127], v[252:255], v[60:63], v[112:127]
    buffer_load_dwordx4 v[176:179], v222, s[24:27], s62 offen nt
    v_exp_f32 v21, v21
    v_exp_f32 v22, v22
    v_exp_f32 v23, v23
    v_exp_f32 v24, v24
    s_waitcnt vmcnt(15)
    v_mfma_f32_32x32x16_bf16 v[32:47], a[28:31], v[224:227], v[184:199]
    v_exp_f32 v25, v25
    v_exp_f32 v26, v26
    v_exp_f32 v27, v27
    v_exp_f32 v28, v28
    buffer_load_dwordx4 v[180:183], v222, s[24:27], s62 offen offset:16 nt
    v_exp_f32 v29, v29
    v_exp_f32 v30, v30
    v_exp_f32 v31, v31
    v_cvt_pk_bf16_f32 v48, v16, v17
    v_cvt_pk_bf16_f32 v49, v18, v19
    v_cvt_pk_bf16_f32 v50, v20, v21
    v_cvt_pk_bf16_f32 v51, v22, v23
    v_cvt_pk_bf16_f32 v52, v24, v25
    v_cvt_pk_bf16_f32 v53, v26, v27
    v_cvt_pk_bf16_f32 v54, v28, v29
    v_cvt_pk_bf16_f32 v55, v30, v31
    s_nop 1
    v_mfma_f32_32x32x16_bf16 v[112:127], v[240:243], v[48:51], v[112:127]
    v_mfma_f32_32x32x16_bf16 v[112:127], v[244:247], v[52:55], v[112:127]
    s_cmp_le_u32 s83, 0
    s_cbranch_scc1 L_attn_j0_18
    v_exp_f32 v32, v32
    v_exp_f32 v33, v33
    v_exp_f32 v34, v34
    v_exp_f32 v35, v35
    v_exp_f32 v36, v36
    s_sub_u32 s90, s56, 16128
    buffer_load_dwordx4 a[4:7], v13, s[40:43], s90 offen sc1
    v_exp_f32 v37, v37
    v_exp_f32 v38, v38
    v_exp_f32 v39, v39
    v_exp_f32 v40, v40
    v_mfma_f32_32x32x16_bf16 v[16:31], a[28:31], v[228:231], v[160:175]
    v_exp_f32 v41, v41
    v_exp_f32 v42, v42
    v_exp_f32 v43, v43
    v_exp_f32 v44, v44
    buffer_load_dwordx4 a[40:43], v11, s[40:43], s90 offen offset:1024 sc1
    buffer_load_dwordx4 a[44:47], v11, s[40:43], s90 offen offset:1664 sc1
    v_exp_f32 v45, v45
    v_exp_f32 v46, v46
    v_exp_f32 v47, v47
    v_cvt_pk_bf16_f32 v56, v32, v33
    v_cvt_pk_bf16_f32 v57, v34, v35
    v_cvt_pk_bf16_f32 v58, v36, v37
    v_cvt_pk_bf16_f32 v59, v38, v39
    v_cvt_pk_bf16_f32 v60, v40, v41
    v_cvt_pk_bf16_f32 v61, v42, v43
    v_cvt_pk_bf16_f32 v62, v44, v45
    v_cvt_pk_bf16_f32 v63, v46, v47
    v_exp_f32 v16, v16
    v_exp_f32 v17, v17
    v_mfma_f32_32x32x16_bf16 v[96:111], a[88:91], v[56:59], v[96:111]
    v_exp_f32 v18, v18
    v_exp_f32 v19, v19
    v_exp_f32 v20, v20
    v_mfma_f32_32x32x16_bf16 v[96:111], a[92:95], v[60:63], v[96:111]
    s_sub_u32 s90, s56, 18432
    buffer_load_dwordx4 a[0:3], v13, s[40:43], s90 offen sc1
    v_exp_f32 v21, v21
    v_exp_f32 v22, v22
    v_exp_f32 v23, v23
    v_exp_f32 v24, v24
    v_mfma_f32_32x32x16_bf16 v[32:47], a[24:27], v[224:227], v[184:199]
    v_exp_f32 v25, v25
    v_exp_f32 v26, v26
    v_exp_f32 v27, v27
    v_exp_f32 v28, v28
    buffer_load_dwordx4 a[32:35], v11, s[40:43], s90 offen offset:1024 sc1
    buffer_load_dwordx4 a[36:39], v11, s[40:43], s90 offen offset:1664 sc1
    v_exp_f32 v29, v29
    v_exp_f32 v30, v30
    v_exp_f32 v31, v31
    v_cvt_pk_bf16_f32 v48, v16, v17
    v_cvt_pk_bf16_f32 v49, v18, v19
    v_cvt_pk_bf16_f32 v50, v20, v21
    v_cvt_pk_bf16_f32 v51, v22, v23
    v_cvt_pk_bf16_f32 v52, v24, v25
    v_cvt_pk_bf16_f32 v53, v26, v27
    v_cvt_pk_bf16_f32 v54, v28, v29
    v_cvt_pk_bf16_f32 v55, v30, v31
    v_exp_f32 v32, v32
    v_exp_f32 v33, v33
    v_mfma_f32_32x32x16_bf16 v[112:127], a[88:91], v[48:51], v[112:127]
    v_exp_f32 v34, v34
    v_exp_f32 v35, v35
    v_exp_f32 v36, v36
    v_mfma_f32_32x32x16_bf16 v[112:127], a[92:95], v[52:55], v[112:127]
    v_exp_f32 v37, v37
    v_exp_f32 v38, v38
    v_exp_f32 v39, v39
    v_exp_f32 v40, v40
    v_mfma_f32_32x32x16_bf16 v[16:31], a[24:27], v[228:231], v[160:175]
    v_exp_f32 v41, v41
    v_exp_f32 v42, v42
    v_exp_f32 v43, v43
    v_exp_f32 v44, v44
    v_exp_f32 v45, v45
    v_exp_f32 v46, v46
    v_exp_f32 v47, v47
    v_cvt_pk_bf16_f32 v56, v32, v33
    v_cvt_pk_bf16_f32 v57, v34, v35
    v_cvt_pk_bf16_f32 v58, v36, v37
    v_cvt_pk_bf16_f32 v59, v38, v39
    v_cvt_pk_bf16_f32 v60, v40, v41
    v_cvt_pk_bf16_f32 v61, v42, v43
    v_cvt_pk_bf16_f32 v62, v44, v45
    v_cvt_pk_bf16_f32 v63, v46, v47
    v_exp_f32 v16, v16
    v_exp_f32 v17, v17
    v_mfma_f32_32x32x16_bf16 v[96:111], a[80:83], v[56:59], v[96:111]
    v_exp_f32 v18, v18
    v_exp_f32 v19, v19
    v_exp_f32 v20, v20
    v_mfma_f32_32x32x16_bf16 v[96:111], a[84:87], v[60:63], v[96:111]
    v_exp_f32 v21, v21
    v_exp_f32 v22, v22
    v_exp_f32 v23, v23
    v_exp_f32 v24, v24
    s_waitcnt vmcnt(14)
    buffer_store_dwordx2 v[8:9], v10, s[40:43], s19 offen sc1
    v_mfma_f32_32x32x16_bf16 v[32:47], a[20:23], v[224:227], v[184:199]
    v_exp_f32 v25, v25
    v_exp_f32 v26, v26
    v_exp_f32 v27, v27
    v_exp_f32 v28, v28
    v_exp_f32 v29, v29
    v_exp_f32 v30, v30
    v_exp_f32 v31, v31
    v_cvt_pk_bf16_f32 v48, v16, v17
    v_cvt_pk_bf16_f32 v49, v18, v19
    v_cvt_pk_bf16_f32 v50, v20, v21
    v_cvt_pk_bf16_f32 v51, v22, v23
    v_cvt_pk_bf16_f32 v52, v24, v25
    v_cvt_pk_bf16_f32 v53, v26, v27
    v_cvt_pk_bf16_f32 v54, v28, v29
    v_cvt_pk_bf16_f32 v55, v30, v31
    s_nop 1
    v_mfma_f32_32x32x16_bf16 v[112:127], a[80:83], v[48:51], v[112:127]
    v_mfma_f32_32x32x16_bf16 v[112:127], a[84:87], v[52:55], v[112:127]
    s_cmp_le_u32 s83, 1
    s_cbranch_scc1 L_attn_done_15
    v_exp_f32 v32, v32
    v_exp_f32 v33, v33
    v_exp_f32 v34, v34
    v_exp_f32 v35, v35
    v_exp_f32 v36, v36
    v_exp_f32 v37, v37
    v_exp_f32 v38, v38
    v_exp_f32 v39, v39
    v_exp_f32 v40, v40
    v_mfma_f32_32x32x16_bf16 v[16:31], a[20:23], v[228:231], v[160:175]
    v_exp_f32 v41, v41
    v_exp_f32 v42, v42
    v_exp_f32 v43, v43
    v_exp_f32 v44, v44
    v_exp_f32 v45, v45
    v_exp_f32 v46, v46
    v_exp_f32 v47, v47
    v_cvt_pk_bf16_f32 v56, v32, v33
    v_cvt_pk_bf16_f32 v57, v34, v35
    v_cvt_pk_bf16_f32 v58, v36, v37
    v_cvt_pk_bf16_f32 v59, v38, v39
    v_cvt_pk_bf16_f32 v60, v40, v41
    v_cvt_pk_bf16_f32 v61, v42, v43
    v_cvt_pk_bf16_f32 v62, v44, v45
    v_cvt_pk_bf16_f32 v63, v46, v47
    v_exp_f32 v16, v16
    v_exp_f32 v17, v17
    v_mfma_f32_32x32x16_bf16 v[96:111], a[72:75], v[56:59], v[96:111]
    v_exp_f32 v18, v18
    v_exp_f32 v19, v19
    v_exp_f32 v20, v20
    v_mfma_f32_32x32x16_bf16 v[96:111], a[76:79], v[60:63], v[96:111]
    v_exp_f32 v21, v21
    v_exp_f32 v22, v22
    v_exp_f32 v23, v23
    v_exp_f32 v24, v24
    v_mfma_f32_32x32x16_bf16 v[32:47], a[16:19], v[224:227], v[184:199]
    v_exp_f32 v25, v25
    v_exp_f32 v26, v26
    v_exp_f32 v27, v27
    v_exp_f32 v28, v28
    v_exp_f32 v29, v29
    v_exp_f32 v30, v30
    v_exp_f32 v31, v31
    v_cvt_pk_bf16_f32 v48, v16, v17
    v_cvt_pk_bf16_f32 v49, v18, v19
    v_cvt_pk_bf16_f32 v50, v20, v21
    v_cvt_pk_bf16_f32 v51, v22, v23
    v_cvt_pk_bf16_f32 v52, v24, v25
    v_cvt_pk_bf16_f32 v53, v26, v27
    v_cvt_pk_bf16_f32 v54, v28, v29
    v_cvt_pk_bf16_f32 v55, v30, v31
    v_exp_f32 v32, v32
    v_exp_f32 v33, v33
    v_mfma_f32_32x32x16_bf16 v[112:127], a[72:75], v[48:51], v[112:127]
    v_exp_f32 v34, v34
    v_exp_f32 v35, v35
    v_exp_f32 v36, v36
    v_mfma_f32_32x32x16_bf16 v[112:127], a[76:79], v[52:55], v[112:127]
    v_exp_f32 v37, v37
    v_exp_f32 v38, v38
    v_exp_f32 v39, v39
    v_exp_f32 v40, v40
    v_mfma_f32_32x32x16_bf16 v[16:31], a[16:19], v[228:231], v[160:175]
    v_exp_f32 v41, v41
    v_exp_f32 v42, v42
    v_exp_f32 v43, v43
    v_exp_f32 v44, v44
    v_exp_f32 v45, v45
    v_exp_f32 v46, v46
    v_exp_f32 v47, v47
    v_cvt_pk_bf16_f32 v56, v32, v33
    v_cvt_pk_bf16_f32 v57, v34, v35
    v_cvt_pk_bf16_f32 v58, v36, v37
    v_cvt_pk_bf16_f32 v59, v38, v39
    v_cvt_pk_bf16_f32 v60, v40, v41
    v_cvt_pk_bf16_f32 v61, v42, v43
    v_cvt_pk_bf16_f32 v62, v44, v45
    v_cvt_pk_bf16_f32 v63, v46, v47
    v_exp_f32 v16, v16
    v_exp_f32 v17, v17
    v_mfma_f32_32x32x16_bf16 v[96:111], a[64:67], v[56:59], v[96:111]
    v_exp_f32 v18, v18
    v_exp_f32 v19, v19
    v_exp_f32 v20, v20
    v_mfma_f32_32x32x16_bf16 v[96:111], a[68:71], v[60:63], v[96:111]
    v_exp_f32 v21, v21
    v_exp_f32 v22, v22
    v_exp_f32 v23, v23
    v_exp_f32 v24, v24
    s_waitcnt vmcnt(9)
    v_mfma_f32_32x32x16_bf16 v[32:47], a[12:15], v[224:227], v[184:199]
    v_exp_f32 v25, v25
    v_exp_f32 v26, v26
    v_exp_f32 v27, v27
    v_exp_f32 v28, v28
    v_exp_f32 v29, v29
    v_exp_f32 v30, v30
    v_exp_f32 v31, v31
    v_cvt_pk_bf16_f32 v48, v16, v17
    v_cvt_pk_bf16_f32 v49, v18, v19
    v_cvt_pk_bf16_f32 v50, v20, v21
    v_cvt_pk_bf16_f32 v51, v22, v23
    v_cvt_pk_bf16_f32 v52, v24, v25
    v_cvt_pk_bf16_f32 v53, v26, v27
    v_cvt_pk_bf16_f32 v54, v28, v29
    v_cvt_pk_bf16_f32 v55, v30, v31
    s_nop 1
    v_mfma_f32_32x32x16_bf16 v[112:127], a[64:67], v[48:51], v[112:127]
    v_mfma_f32_32x32x16_bf16 v[112:127], a[68:71], v[52:55], v[112:127]
    s_cmp_le_u32 s83, 2
    s_cbranch_scc1 L_attn_done_15
    v_exp_f32 v32, v32
    v_exp_f32 v33, v33
    v_exp_f32 v34, v34
    v_exp_f32 v35, v35
    v_exp_f32 v36, v36
    v_exp_f32 v37, v37
    v_exp_f32 v38, v38
    v_exp_f32 v39, v39
    v_exp_f32 v40, v40
    v_mfma_f32_32x32x16_bf16 v[16:31], a[12:15], v[228:231], v[160:175]
    v_exp_f32 v41, v41
    v_exp_f32 v42, v42
    v_exp_f32 v43, v43
    v_exp_f32 v44, v44
    v_exp_f32 v45, v45
    v_exp_f32 v46, v46
    v_exp_f32 v47, v47
    v_cvt_pk_bf16_f32 v56, v32, v33
    v_cvt_pk_bf16_f32 v57, v34, v35
    v_cvt_pk_bf16_f32 v58, v36, v37
    v_cvt_pk_bf16_f32 v59, v38, v39
    v_cvt_pk_bf16_f32 v60, v40, v41
    v_cvt_pk_bf16_f32 v61, v42, v43
    v_cvt_pk_bf16_f32 v62, v44, v45
    v_cvt_pk_bf16_f32 v63, v46, v47
    v_exp_f32 v16, v16
    v_exp_f32 v17, v17
    v_mfma_f32_32x32x16_bf16 v[96:111], a[56:59], v[56:59], v[96:111]
    v_exp_f32 v18, v18
    v_exp_f32 v19, v19
    v_exp_f32 v20, v20
    v_mfma_f32_32x32x16_bf16 v[96:111], a[60:63], v[60:63], v[96:111]
    v_exp_f32 v21, v21
    v_exp_f32 v22, v22
    v_exp_f32 v23, v23
    v_exp_f32 v24, v24
    v_mfma_f32_32x32x16_bf16 v[32:47], a[8:11], v[224:227], v[184:199]
    v_exp_f32 v25, v25
    v_exp_f32 v26, v26
    v_exp_f32 v27, v27
    v_exp_f32 v28, v28
    v_exp_f32 v29, v29
    v_exp_f32 v30, v30
    v_exp_f32 v31, v31
    v_cvt_pk_bf16_f32 v48, v16, v17
    v_cvt_pk_bf16_f32 v49, v18, v19
    v_cvt_pk_bf16_f32 v50, v20, v21
    v_cvt_pk_bf16_f32 v51, v22, v23
    v_cvt_pk_bf16_f32 v52, v24, v25
    v_cvt_pk_bf16_f32 v53, v26, v27
    v_cvt_pk_bf16_f32 v54, v28, v29
    v_cvt_pk_bf16_f32 v55, v30, v31
    v_exp_f32 v32, v32
    v_exp_f32 v33, v33
    v_mfma_f32_32x32x16_bf16 v[112:127], a[56:59], v[48:51], v[112:127]
    v_exp_f32 v34, v34
    v_exp_f32 v35, v35
    v_exp_f32 v36, v36
    v_mfma_f32_32x32x16_bf16 v[112:127], a[60:63], v[52:55], v[112:127]
    v_exp_f32 v37, v37
    v_exp_f32 v38, v38
    v_exp_f32 v39, v39
    v_exp_f32 v40, v40
    v_mfma_f32_32x32x16_bf16 v[16:31], a[8:11], v[228:231], v[160:175]
    v_exp_f32 v41, v41
    v_exp_f32 v42, v42
    v_exp_f32 v43, v43
    v_exp_f32 v44, v44
    v_exp_f32 v45, v45
    v_exp_f32 v46, v46
    v_exp_f32 v47, v47
    v_cvt_pk_bf16_f32 v56, v32, v33
    v_cvt_pk_bf16_f32 v57, v34, v35
    v_cvt_pk_bf16_f32 v58, v36, v37
    v_cvt_pk_bf16_f32 v59, v38, v39
    v_cvt_pk_bf16_f32 v60, v40, v41
    v_cvt_pk_bf16_f32 v61, v42, v43
    v_cvt_pk_bf16_f32 v62, v44, v45
    v_cvt_pk_bf16_f32 v63, v46, v47
    v_exp_f32 v16, v16
    v_exp_f32 v17, v17
    v_mfma_f32_32x32x16_bf16 v[96:111], a[48:51], v[56:59], v[96:111]
    v_exp_f32 v18, v18
    v_exp_f32 v19, v19
    v_exp_f32 v20, v20
    v_mfma_f32_32x32x16_bf16 v[96:111], a[52:55], v[60:63], v[96:111]
    v_exp_f32 v21, v21
    v_exp_f32 v22, v22
    v_exp_f32 v23, v23
    v_exp_f32 v24, v24
    s_waitcnt vmcnt(1)
    v_mfma_f32_32x32x16_bf16 v[32:47], a[4:7], v[224:227], v[184:199]
    v_exp_f32 v25, v25
    v_exp_f32 v26, v26
    v_exp_f32 v27, v27
    v_exp_f32 v28, v28
    v_exp_f32 v29, v29
    v_exp_f32 v30, v30
    v_exp_f32 v31, v31
    v_cvt_pk_bf16_f32 v48, v16, v17
    v_cvt_pk_bf16_f32 v49, v18, v19
    v_cvt_pk_bf16_f32 v50, v20, v21
    v_cvt_pk_bf16_f32 v51, v22, v23
    v_cvt_pk_bf16_f32 v52, v24, v25
    v_cvt_pk_bf16_f32 v53, v26, v27
    v_cvt_pk_bf16_f32 v54, v28, v29
    v_cvt_pk_bf16_f32 v55, v30, v31
    s_nop 1
    v_mfma_f32_32x32x16_bf16 v[112:127], a[48:51], v[48:51], v[112:127]
    v_mfma_f32_32x32x16_bf16 v[112:127], a[52:55], v[52:55], v[112:127]
    s_cmp_le_u32 s83, 3
    s_cbranch_scc1 L_attn_done_15
    v_exp_f32 v32, v32
    v_exp_f32 v33, v33
    v_exp_f32 v34, v34
    v_exp_f32 v35, v35
    v_exp_f32 v36, v36
    buffer_load_dwordx2 v[218:219], v7, s[40:43], s22 offen sc1
    v_exp_f32 v37, v37
    v_exp_f32 v38, v38
    v_exp_f32 v39, v39
    v_exp_f32 v40, v40
    v_mfma_f32_32x32x16_bf16 v[16:31], a[4:7], v[228:231], v[160:175]
    v_exp_f32 v41, v41
    v_exp_f32 v42, v42
    v_exp_f32 v43, v43
    v_exp_f32 v44, v44
    buffer_load_dwordx2 v[220:221], v7, s[40:43], s23 offen sc1
    v_exp_f32 v45, v45
    v_exp_f32 v46, v46
    v_exp_f32 v47, v47
    v_cvt_pk_bf16_f32 v56, v32, v33
    v_cvt_pk_bf16_f32 v57, v34, v35
    v_cvt_pk_bf16_f32 v58, v36, v37
    v_cvt_pk_bf16_f32 v59, v38, v39
    v_cvt_pk_bf16_f32 v60, v40, v41
    v_cvt_pk_bf16_f32 v61, v42, v43
    v_cvt_pk_bf16_f32 v62, v44, v45
    v_cvt_pk_bf16_f32 v63, v46, v47
    v_exp_f32 v16, v16
    v_exp_f32 v17, v17
    v_mfma_f32_32x32x16_bf16 v[96:111], a[40:43], v[56:59], v[96:111]
    v_exp_f32 v18, v18
    v_exp_f32 v19, v19
    v_exp_f32 v20, v20
    v_mfma_f32_32x32x16_bf16 v[96:111], a[44:47], v[60:63], v[96:111]
    v_exp_f32 v21, v21
    v_exp_f32 v22, v22
    v_exp_f32 v23, v23
    v_exp_f32 v24, v24
    v_mfma_f32_32x32x16_bf16 v[32:47], a[0:3], v[224:227], v[184:199]
    v_exp_f32 v25, v25
    v_exp_f32 v26, v26
    v_exp_f32 v27, v27
    v_exp_f32 v28, v28
    v_exp_f32 v29, v29
    v_exp_f32 v30, v30
    v_exp_f32 v31, v31
    v_cvt_pk_bf16_f32 v48, v16, v17
    v_cvt_pk_bf16_f32 v49, v18, v19
    v_cvt_pk_bf16_f32 v50, v20, v21
    v_cvt_pk_bf16_f32 v51, v22, v23
    v_cvt_pk_bf16_f32 v52, v24, v25
    v_cvt_pk_bf16_f32 v53, v26, v27
    v_cvt_pk_bf16_f32 v54, v28, v29
    v_cvt_pk_bf16_f32 v55, v30, v31
    v_bfi_b32 v48, v200, 0, v48
    v_bfi_b32 v49, v201, 0, v49
    v_bfi_b32 v50, v202, 0, v50
    v_bfi_b32 v51, v203, 0, v51
    v_bfi_b32 v52, v204, 0, v52
    v_bfi_b32 v53, v205, 0, v53
    v_bfi_b32 v54, v206, 0, v54
    v_bfi_b32 v55, v207, 0, v55
    v_exp_f32 v32, v32
    v_exp_f32 v33, v33
    v_mfma_f32_32x32x16_bf16 v[112:127], a[40:43], v[48:51], v[112:127]
    v_exp_f32 v34, v34
    v_exp_f32 v35, v35
    v_exp_f32 v36, v36
    v_mfma_f32_32x32x16_bf16 v[112:127], a[44:47], v[52:55], v[112:127]
    v_exp_f32 v37, v37
    v_exp_f32 v38, v38
    v_exp_f32 v39, v39
    v_exp_f32 v40, v40
    v_exp_f32 v41, v41
    v_exp_f32 v42, v42
    v_exp_f32 v43, v43
    v_exp_f32 v44, v44
    v_exp_f32 v45, v45
    v_exp_f32 v46, v46
    v_exp_f32 v47, v47
    v_cvt_pk_bf16_f32 v56, v32, v33
    v_cvt_pk_bf16_f32 v57, v34, v35
    v_cvt_pk_bf16_f32 v58, v36, v37
    v_cvt_pk_bf16_f32 v59, v38, v39
    v_cvt_pk_bf16_f32 v60, v40, v41
    v_cvt_pk_bf16_f32 v61, v42, v43
    v_cvt_pk_bf16_f32 v62, v44, v45
    v_cvt_pk_bf16_f32 v63, v46, v47
    v_bfi_b32 v56, v200, 0, v56
    v_bfi_b32 v57, v201, 0, v57
    v_bfi_b32 v58, v202, 0, v58
    v_bfi_b32 v59, v203, 0, v59
    v_bfi_b32 v60, v204, 0, v60
    v_bfi_b32 v61, v205, 0, v61
    v_bfi_b32 v62, v206, 0, v62
    v_bfi_b32 v63, v207, 0, v63
    s_nop 1
    v_mfma_f32_32x32x16_bf16 v[96:111], a[32:35], v[56:59], v[96:111]
    v_mfma_f32_32x32x16_bf16 v[96:111], a[36:39], v[60:63], v[96:111]
L_attn_done_15:
    s_nop 7
    s_nop 3
    v_mov_b32 v2, v104
    v_mov_b32 v4, v104
    s_nop 1
    v_permlane32_swap_b32 v2, v4
    v_mov_b32 v3, v120
    v_mov_b32 v4, v120
    s_nop 1
    v_permlane32_swap_b32 v3, v4
    s_mov_b32 s84, 0x71800000
    v_max_f32 v4, v2, v3
    s_nop 0
    v_cmp_gt_f32 vcc, s84, v4
    s_nop 3
    s_mov_b64 s[86:87], vcc
    v_cmp_o_f32 vcc, v2, v3
    s_nop 4
    s_and_b64 s[86:87], s[86:87], vcc
    s_cmp_lg_u32 s94, 0
    s_cbranch_scc1 L_attn_ok_17
    s_cmp_eq_u64 s[86:87], -1
    s_cbranch_scc0 L_attn_fallback_16
L_attn_ok_17:
    v_rcp_f32 v2, v2
    v_rcp_f32 v3, v3
    v_mul_f32 v96, v96, v2
    v_mul_f32 v97, v97, v2
    v_mul_f32 v98, v98, v2
    v_mul_f32 v99, v99, v2
    v_mul_f32 v100, v100, v2
    v_mul_f32 v101, v101, v2
    v_mul_f32 v102, v102, v2
    v_mul_f32 v103, v103, v2
    v_cvt_pk_bf16_f32 v16, v96, v97
    v_cvt_pk_bf16_f32 v17, v98, v99
    v_cvt_pk_bf16_f32 v18, v100, v101
    v_cvt_pk_bf16_f32 v19, v102, v103
    buffer_store_dwordx4 v[16:19], v12, s[40:43], s99 offen sc1
    v_mul_f32 v112, v112, v3
    v_mul_f32 v113, v113, v3
    v_mul_f32 v114, v114, v3
    v_mul_f32 v115, v115, v3
    v_mul_f32 v116, v116, v3
    v_mul_f32 v117, v117, v3
    v_mul_f32 v118, v118, v3
    v_mul_f32 v119, v119, v3
    v_cvt_pk_bf16_f32 v20, v112, v113
    v_cvt_pk_bf16_f32 v21, v114, v115
    v_cvt_pk_bf16_f32 v22, v116, v117
    v_cvt_pk_bf16_f32 v23, v118, v119
    s_add_u32 s85, s99, 32768
    buffer_store_dwordx4 v[20:23], v12, s[40:43], s85 offen sc1
    s_waitcnt vmcnt(2)
    s_mov_b32 s55, 0
    s_branch L_f3_chk_22
L_f3_20:
    s_sleep 2
    buffer_load_dwordx2 v[218:219], v7, s[40:43], s22 offen sc1
    s_waitcnt vmcnt(0)
L_f3_chk_22:
    s_add_u32 s55, s55, 1
    v_cmp_ne_u64 vcc, s[52:53], v[218:219]
    s_nop 0
    s_and_b32 vcc_lo, vcc_lo, 0xffff
    s_cbranch_scc0 L_f3_done_21
    s_cmp_lt_u32 s55, 0x20000
    s_cbranch_scc1 L_f3_20
L_f3_done_21:
    s_add_u32 s90, s58, 32768
    buffer_load_dwordx4 v[64:67], v223, s[40:43], s58 offen sc1
    buffer_load_dwordx4 v[68:71], v223, s[40:43], s90 offen sc1
    s_mov_b32 s55, 0
    s_branch L_f5_chk_25
L_f5_23:
    s_sleep 2
    buffer_load_dwordx2 v[220:221], v7, s[40:43], s23 offen sc1
    s_waitcnt vmcnt(0)
L_f5_chk_25:
    s_add_u32 s55, s55, 1
    v_cmp_ne_u64 vcc, s[52:53], v[220:221]
    s_nop 0
    s_and_b32 vcc_lo, vcc_lo, -1
    s_cbranch_scc0 L_f5_done_24
    s_cmp_lt_u32 s55, 0x20000
    s_cbranch_scc1 L_f5_23
L_f5_done_24:
    s_lshl_b32 s84, s3, 11
    s_add_u32 s84, s84, 140800
    v_add_u32 v25, s84, v13
    v_lshrrev_b32 v6, 4, v1
    v_bfe_u32 v3, v1, 2, 2
    v_lshl_add_u32 v4, v6, 4, v3
    v_lshlrev_b32 v4, 7, v4
    v_and_b32 v5, 3, v1
    v_lshl_add_u32 v4, v5, 3, v4
    s_lshl_b32 s84, s3, 5
    s_add_u32 s84, s84, 140800
    v_add_u32 v26, s84, v4
    v_and_b32 v4, 15, v1
    v_lshlrev_b32 v4, 11, v4
    v_lshl_add_u32 v27, v6, 5, v4
    v_lshlrev_b32 v32, 16, v176
    v_and_b32 v33, 0xffff0000, v176
    v_lshlrev_b32 v34, 16, v177
    v_and_b32 v35, 0xffff0000, v177
    v_lshlrev_b32 v36, 16, v178
    v_and_b32 v37, 0xffff0000, v178
    v_lshlrev_b32 v38, 16, v179
    v_and_b32 v39, 0xffff0000, v179
    v_lshlrev_b32 v40, 16, v180
    v_and_b32 v41, 0xffff0000, v180
    v_lshlrev_b32 v42, 16, v181
    v_and_b32 v43, 0xffff0000, v181
    v_lshlrev_b32 v44, 16, v182
    v_and_b32 v45, 0xffff0000, v182
    v_lshlrev_b32 v46, 16, v183
    v_and_b32 v47, 0xffff0000, v183
    v_lshrrev_b32 v2, 5, v1
    v_bfe_u32 v4, v1, 4, 1
    v_lshlrev_b32 v6, 4, v2
    v_lshl_add_u32 v6, v4, 2, v6
    v_add_u32 v6, v6, v3
    v_lshlrev_b32 v6, 7, v6
    v_lshl_add_u32 v6, v5, 3, v6
    v_lshrrev_b32 v3, 1, v3
    v_lshl_add_u32 v3, v4, 1, v3
    v_xor_b32 v5, 0, v3
    v_lshl_add_u32 v84, v5, 5, v6
    v_xor_b32 v5, 1, v3
    v_lshl_add_u32 v85, v5, 5, v6
    v_xor_b32 v5, 2, v3
    v_lshl_add_u32 v86, v5, 5, v6
    v_xor_b32 v5, 3, v3
    v_lshl_add_u32 v87, v5, 5, v6
    v_and_b32 v5, 15, v1
    v_lshlrev_b32 v30, 11, v5
    v_lshl_add_u32 v30, v4, 5, v30
    v_lshl_add_u32 v30, v2, 4, v30
    ds_read_b64_tr_b16 a[0:1], v84 offset:0
    ds_read_b64_tr_b16 a[2:3], v84 offset:1024
    ds_read_b64_tr_b16 a[4:5], v85 offset:0
    ds_read_b64_tr_b16 a[6:7], v85 offset:1024
    ds_read_b64_tr_b16 a[8:9], v86 offset:0
    ds_read_b64_tr_b16 a[10:11], v86 offset:1024
    ds_read_b64_tr_b16 a[12:13], v87 offset:0
    ds_read_b64_tr_b16 a[14:15], v87 offset:1024
    ds_read_b64_tr_b16 a[16:17], v84 offset:4096
    ds_read_b64_tr_b16 a[18:19], v84 offset:5120
    ds_read_b64_tr_b16 a[20:21], v85 offset:4096
    ds_read_b64_tr_b16 a[22:23], v85 offset:5120
    ds_read_b64_tr_b16 a[24:25], v86 offset:4096
    ds_read_b64_tr_b16 a[26:27], v86 offset:5120
    ds_read_b64_tr_b16 a[28:29], v87 offset:4096
    ds_read_b64_tr_b16 a[30:31], v87 offset:5120
    ds_read_b64_tr_b16 a[32:33], v84 offset:8192
    ds_read_b64_tr_b16 a[34:35], v84 offset:9216
    ds_read_b64_tr_b16 a[36:37], v85 offset:8192
    ds_read_b64_tr_b16 a[38:39], v85 offset:9216
    ds_read_b64_tr_b16 a[40:41], v86 offset:8192
    ds_read_b64_tr_b16 a[42:43], v86 offset:9216
    ds_read_b64_tr_b16 a[44:45], v87 offset:8192
    ds_read_b64_tr_b16 a[46:47], v87 offset:9216
    ds_read_b64_tr_b16 a[48:49], v84 offset:12288
    ds_read_b64_tr_b16 a[50:51], v84 offset:13312
    ds_read_b64_tr_b16 a[52:53], v85 offset:12288
    ds_read_b64_tr_b16 a[54:55], v85 offset:13312
    ds_read_b64_tr_b16 a[56:57], v86 offset:12288
    ds_read_b64_tr_b16 a[58:59], v86 offset:13312
    ds_read_b64_tr_b16 a[60:61], v87 offset:12288
    ds_read_b64_tr_b16 a[62:63], v87 offset:13312
    ds_read_b64_tr_b16 a[64:65], v84 offset:16384
    ds_read_b64_tr_b16 a[66:67], v84 offset:17408
    ds_read_b64_tr_b16 a[68:69], v85 offset:16384
    ds_read_b64_tr_b16 a[70:71], v85 offset:17408
    ds_read_b64_tr_b16 a[72:73], v86 offset:16384
    ds_read_b64_tr_b16 a[74:75], v86 offset:17408
    ds_read_b64_tr_b16 a[76:77], v87 offset:16384
    ds_read_b64_tr_b16 a[78:79], v87 offset:17408
    ds_read_b64_tr_b16 a[80:81], v84 offset:20480
    ds_read_b64_tr_b16 a[82:83], v84 offset:21504
    ds_read_b64_tr_b16 a[84:85], v85 offset:20480
    ds_read_b64_tr_b16 a[86:87], v85 offset:21504
    ds_read_b64_tr_b16 a[88:89], v86 offset:20480
    ds_read_b64_tr_b16 a[90:91], v86 offset:21504
    ds_read_b64_tr_b16 a[92:93], v87 offset:20480
    ds_read_b64_tr_b16 a[94:95], v87 offset:21504
    ds_read_b64_tr_b16 a[96:97], v84 offset:24576
    ds_read_b64_tr_b16 a[98:99], v84 offset:25600
    ds_read_b64_tr_b16 a[100:101], v85 offset:24576
    ds_read_b64_tr_b16 a[102:103], v85 offset:25600
    ds_read_b64_tr_b16 a[104:105], v86 offset:24576
    ds_read_b64_tr_b16 a[106:107], v86 offset:25600
    ds_read_b64_tr_b16 a[108:109], v87 offset:24576
    ds_read_b64_tr_b16 a[110:111], v87 offset:25600
    ds_read_b64_tr_b16 a[112:113], v84 offset:28672
    ds_read_b64_tr_b16 a[114:115], v84 offset:29696
    ds_read_b64_tr_b16 a[116:117], v85 offset:28672
    ds_read_b64_tr_b16 a[118:119], v85 offset:29696
    ds_read_b64_tr_b16 a[120:121], v86 offset:28672
    ds_read_b64_tr_b16 a[122:123], v86 offset:29696
    ds_read_b64_tr_b16 a[124:125], v87 offset:28672
    ds_read_b64_tr_b16 a[126:127], v87 offset:29696
    ds_read_b64_tr_b16 a[128:129], v84 offset:32768
    ds_read_b64_tr_b16 a[130:131], v84 offset:33792
    ds_read_b64_tr_b16 a[132:133], v85 offset:32768
    ds_read_b64_tr_b16 a[134:135], v85 offset:33792
    ds_read_b64_tr_b16 a[136:137], v86 offset:32768
    ds_read_b64_tr_b16 a[138:139], v86 offset:33792
    ds_read_b64_tr_b16 a[140:141], v87 offset:32768
    ds_read_b64_tr_b16 a[142:143], v87 offset:33792
    ds_read_b64_tr_b16 a[144:145], v84 offset:36864
    ds_read_b64_tr_b16 a[146:147], v84 offset:37888
    ds_read_b64_tr_b16 a[148:149], v85 offset:36864
    ds_read_b64_tr_b16 a[150:151], v85 offset:37888
    ds_read_b64_tr_b16 a[152:153], v86 offset:36864
    ds_read_b64_tr_b16 a[154:155], v86 offset:37888
    ds_read_b64_tr_b16 a[156:157], v87 offset:36864
    ds_read_b64_tr_b16 a[158:159], v87 offset:37888
    ds_read_b64_tr_b16 a[160:161], v84 offset:40960
    ds_read_b64_tr_b16 a[162:163], v84 offset:41984
    ds_read_b64_tr_b16 a[164:165], v85 offset:40960
    ds_read_b64_tr_b16 a[166:167], v85 offset:41984
    ds_read_b64_tr_b16 a[168:169], v86 offset:40960
    ds_read_b64_tr_b16 a[170:171], v86 offset:41984
    ds_read_b64_tr_b16 a[172:173], v87 offset:40960
    ds_read_b64_tr_b16 a[174:175], v87 offset:41984
    ds_read_b64_tr_b16 a[176:177], v84 offset:45056
    ds_read_b64_tr_b16 a[178:179], v84 offset:46080
    ds_read_b64_tr_b16 a[180:181], v85 offset:45056
    ds_read_b64_tr_b16 a[182:183], v85 offset:46080
    ds_read_b64_tr_b16 a[184:185], v86 offset:45056
    ds_read_b64_tr_b16 a[186:187], v86 offset:46080
    ds_read_b64_tr_b16 a[188:189], v87 offset:45056
    ds_read_b64_tr_b16 a[190:191], v87 offset:46080
    ds_read_b64_tr_b16 a[192:193], v84 offset:49152
    ds_read_b64_tr_b16 a[194:195], v84 offset:50176
    ds_read_b64_tr_b16 a[196:197], v85 offset:49152
    ds_read_b64_tr_b16 a[198:199], v85 offset:50176
    ds_read_b64_tr_b16 a[200:201], v86 offset:49152
    ds_read_b64_tr_b16 a[202:203], v86 offset:50176
    ds_read_b64_tr_b16 a[204:205], v87 offset:49152
    ds_read_b64_tr_b16 a[206:207], v87 offset:50176
    ds_read_b64_tr_b16 a[208:209], v84 offset:53248
    ds_read_b64_tr_b16 a[210:211], v84 offset:54272
    ds_read_b64_tr_b16 a[212:213], v85 offset:53248
    ds_read_b64_tr_b16 a[214:215], v85 offset:54272
    ds_read_b64_tr_b16 a[216:217], v86 offset:53248
    ds_read_b64_tr_b16 a[218:219], v86 offset:54272
    ds_read_b64_tr_b16 a[220:221], v87 offset:53248
    ds_read_b64_tr_b16 a[222:223], v87 offset:54272
    ds_read_b64_tr_b16 a[224:225], v84 offset:57344
    ds_read_b64_tr_b16 a[226:227], v84 offset:58368
    ds_read_b64_tr_b16 a[228:229], v85 offset:57344
    ds_read_b64_tr_b16 a[230:231], v85 offset:58368
    ds_read_b64_tr_b16 a[232:233], v86 offset:57344
    ds_read_b64_tr_b16 a[234:235], v86 offset:58368
    ds_read_b64_tr_b16 a[236:237], v87 offset:57344
    ds_read_b64_tr_b16 a[238:239], v87 offset:58368
    ds_read_b64_tr_b16 a[240:241], v84 offset:61440
    ds_read_b64_tr_b16 a[242:243], v84 offset:62464
    ds_read_b64_tr_b16 a[244:245], v85 offset:61440
    ds_read_b64_tr_b16 a[246:247], v85 offset:62464
    ds_read_b64_tr_b16 a[248:249], v86 offset:61440
    ds_read_b64_tr_b16 a[250:251], v86 offset:62464
    ds_read_b64_tr_b16 a[252:253], v87 offset:61440
    ds_read_b64_tr_b16 a[254:255], v87 offset:62464
    s_waitcnt vmcnt(0)
    ds_write_b128 v25, v[64:67]
    ds_write_b128 v25, v[68:71] offset:1024
    s_waitcnt lgkmcnt(0)
    s_barrier
    ds_read_b64_tr_b16 v[48:49], v26 offset:0
    ds_read_b64_tr_b16 v[50:51], v26 offset:512
    ds_read_b64_tr_b16 v[52:53], v26 offset:1024
    ds_read_b64_tr_b16 v[54:55], v26 offset:1536
    s_waitcnt lgkmcnt(0)
    v_lshlrev_b32 v64, 16, v48
    v_and_b32 v65, 0xffff0000, v48
    v_lshlrev_b32 v66, 16, v49
    s_add_u32 s90, s61, 0
    buffer_load_dwordx4 v[96:99], v13, s[40:43], s90 offen offset:0 sc1
    v_and_b32 v67, 0xffff0000, v49
    v_lshlrev_b32 v68, 16, v50
    v_and_b32 v69, 0xffff0000, v50
    buffer_load_dwordx4 v[100:103], v13, s[40:43], s90 offen offset:1024 sc1
    v_lshlrev_b32 v70, 16, v51
    v_and_b32 v71, 0xffff0000, v51
    v_lshlrev_b32 v72, 16, v52
    buffer_load_dwordx4 v[104:107], v13, s[40:43], s90 offen offset:2048 sc1
    v_and_b32 v73, 0xffff0000, v52
    v_lshlrev_b32 v74, 16, v53
    v_and_b32 v75, 0xffff0000, v53
    buffer_load_dwordx4 v[108:111], v13, s[40:43], s90 offen offset:3072 sc1
    v_lshlrev_b32 v76, 16, v54
    v_and_b32 v77, 0xffff0000, v54
    v_lshlrev_b32 v78, 16, v55
    s_add_u32 s90, s61, 4096
    buffer_load_dwordx4 v[112:115], v13, s[40:43], s90 offen offset:0 sc1
    v_and_b32 v79, 0xffff0000, v55
    v_mul_f32 v32, v32, v64
    v_mul_f32 v33, v33, v65
    buffer_load_dwordx4 v[116:119], v13, s[40:43], s90 offen offset:1024 sc1
    v_mul_f32 v34, v34, v66
    v_mul_f32 v35, v35, v67
    v_mul_f32 v36, v36, v68
    buffer_load_dwordx4 v[120:123], v13, s[40:43], s90 offen offset:2048 sc1
    v_mul_f32 v37, v37, v69
    v_mul_f32 v38, v38, v70
    v_mul_f32 v39, v39, v71
    buffer_load_dwordx4 v[124:127], v13, s[40:43], s90 offen offset:3072 sc1
    v_mul_f32 v40, v40, v72
    v_mul_f32 v41, v41, v73
    v_mul_f32 v42, v42, v74
    s_add_u32 s90, s61, 8192
    buffer_load_dwordx4 v[128:131], v13, s[40:43], s90 offen offset:0 sc1
    v_mul_f32 v43, v43, v75
    v_mul_f32 v44, v44, v76
    v_mul_f32 v45, v45, v77
    buffer_load_dwordx4 v[132:135], v13, s[40:43], s90 offen offset:1024 sc1
    v_mul_f32 v46, v46, v78
    v_mul_f32 v47, v47, v79
    v_cvt_pk_bf16_f32 v16, v32, v33
    buffer_load_dwordx4 v[136:139], v13, s[40:43], s90 offen offset:2048 sc1
    v_cvt_pk_bf16_f32 v17, v34, v35
    v_cvt_pk_bf16_f32 v18, v36, v37
    v_cvt_pk_bf16_f32 v19, v38, v39
    buffer_load_dwordx4 v[140:143], v13, s[40:43], s90 offen offset:3072 sc1
    v_cvt_pk_bf16_f32 v20, v40, v41
    v_cvt_pk_bf16_f32 v21, v42, v43
    v_cvt_pk_bf16_f32 v22, v44, v45
    s_add_u32 s90, s61, 12288
    buffer_load_dwordx4 v[144:147], v13, s[40:43], s90 offen offset:0 sc1
    v_cvt_pk_bf16_f32 v23, v46, v47
    buffer_load_dwordx4 v[148:151], v13, s[40:43], s90 offen offset:1024 sc1
    buffer_load_dwordx4 v[152:155], v13, s[40:43], s90 offen offset:2048 sc1
    buffer_load_dwordx4 v[156:159], v13, s[40:43], s90 offen offset:3072 sc1
    buffer_store_dwordx4 v[16:19], v27, s[36:39], s59 offen
    buffer_store_dwordx4 v[20:23], v27, s[36:39], s59 offen offset:16
    s_mov_b32 s55, 0
    s_waitcnt vmcnt(17)
    v_max3_u32 v31, v96, v97, v98
    v_max_u32 v31, v31, v99
    v_cmp_eq_u32 vcc, -1, v31
    s_nop 3
    s_cbranch_vccnz L_ofchk0_30_r
L_ofok0_31:
    s_waitcnt vmcnt(16)
    v_max3_u32 v31, v100, v101, v102
    v_max_u32 v31, v31, v103
    v_cmp_eq_u32 vcc, -1, v31
    v_mfma_f32_16x16x32_bf16 v[64:67], a[0:3], v[96:99], 0
    v_mfma_f32_16x16x32_bf16 v[68:71], a[4:7], v[96:99], 0
    v_mfma_f32_16x16x32_bf16 v[72:75], a[8:11], v[96:99], 0
    v_mfma_f32_16x16x32_bf16 v[76:79], a[12:15], v[96:99], 0
    s_cbranch_vccnz L_ofchk1_32_r
L_ofok1_33:
    s_waitcnt vmcnt(15)
    v_max3_u32 v31, v104, v105, v106
    v_max_u32 v31, v31, v107
    v_cmp_eq_u32 vcc, -1, v31
    v_mfma_f32_16x16x32_bf16 v[64:67], a[16:19], v[100:103], v[64:67]
    v_mfma_f32_16x16x32_bf16 v[68:71], a[20:23], v[100:103], v[68:71]
    v_mfma_f32_16x16x32_bf16 v[72:75], a[24:27], v[100:103], v[72:75]
    v_mfma_f32_16x16x32_bf16 v[76:79], a[28:31], v[100:103], v[76:79]
    s_cbranch_vccnz L_ofchk2_34_r
L_ofok2_35:
    s_waitcnt vmcnt(14)
    v_max3_u32 v31, v108, v109, v110
    v_max_u32 v31, v31, v111
    v_cmp_eq_u32 vcc, -1, v31
    v_mfma_f32_16x16x32_bf16 v[64:67], a[32:35], v[104:107], v[64:67]
    v_mfma_f32_16x16x32_bf16 v[68:71], a[36:39], v[104:107], v[68:71]
    v_mfma_f32_16x16x32_bf16 v[72:75], a[40:43], v[104:107], v[72:75]
    v_mfma_f32_16x16x32_bf16 v[76:79], a[44:47], v[104:107], v[76:79]
    s_cbranch_vccnz L_ofchk3_36_r
L_ofok3_37:
    s_waitcnt vmcnt(13)
    v_max3_u32 v31, v112, v113, v114
    v_max_u32 v31, v31, v115
    v_cmp_eq_u32 vcc, -1, v31
    v_mfma_f32_16x16x32_bf16 v[64:67], a[48:51], v[108:111], v[64:67]
    v_mfma_f32_16x16x32_bf16 v[68:71], a[52:55], v[108:111], v[68:71]
    v_mfma_f32_16x16x32_bf16 v[72:75], a[56:59], v[108:111], v[72:75]
    v_mfma_f32_16x16x32_bf16 v[76:79], a[60:63], v[108:111], v[76:79]
    s_cbranch_vccnz L_ofchk4_38_r
L_ofok4_39:
    s_waitcnt vmcnt(12)
    v_max3_u32 v31, v116, v117, v118
    v_max_u32 v31, v31, v119
    v_cmp_eq_u32 vcc, -1, v31
    v_mfma_f32_16x16x32_bf16 v[64:67], a[64:67], v[112:115], v[64:67]
    v_mfma_f32_16x16x32_bf16 v[68:71], a[68:71], v[112:115], v[68:71]
    v_mfma_f32_16x16x32_bf16 v[72:75], a[72:75], v[112:115], v[72:75]
    v_mfma_f32_16x16x32_bf16 v[76:79], a[76:79], v[112:115], v[76:79]
    s_cbranch_vccnz L_ofchk5_40_r
L_ofok5_41:
    s_waitcnt vmcnt(11)
    v_max3_u32 v31, v120, v121, v122
    v_max_u32 v31, v31, v123
    v_cmp_eq_u32 vcc, -1, v31
    v_mfma_f32_16x16x32_bf16 v[64:67], a[80:83], v[116:119], v[64:67]
    v_mfma_f32_16x16x32_bf16 v[68:71], a[84:87], v[116:119], v[68:71]
    v_mfma_f32_16x16x32_bf16 v[72:75], a[88:91], v[116:119], v[72:75]
    v_mfma_f32_16x16x32_bf16 v[76:79], a[92:95], v[116:119], v[76:79]
    s_cbranch_vccnz L_ofchk6_42_r
L_ofok6_43:
    s_waitcnt vmcnt(10)
    v_max3_u32 v31, v124, v125, v126
    v_max_u32 v31, v31, v127
    v_cmp_eq_u32 vcc, -1, v31
    v_mfma_f32_16x16x32_bf16 v[64:67], a[96:99], v[120:123], v[64:67]
    v_mfma_f32_16x16x32_bf16 v[68:71], a[100:103], v[120:123], v[68:71]
    v_mfma_f32_16x16x32_bf16 v[72:75], a[104:107], v[120:123], v[72:75]
    v_mfma_f32_16x16x32_bf16 v[76:79], a[108:111], v[120:123], v[76:79]
    s_cbranch_vccnz L_ofchk7_44_r
L_ofok7_45:
    s_waitcnt vmcnt(9)
    v_max3_u32 v31, v128, v129, v130
    v_max_u32 v31, v31, v131
    v_cmp_eq_u32 vcc, -1, v31
    v_mfma_f32_16x16x32_bf16 v[64:67], a[112:115], v[124:127], v[64:67]
    v_mfma_f32_16x16x32_bf16 v[68:71], a[116:119], v[124:127], v[68:71]
    v_mfma_f32_16x16x32_bf16 v[72:75], a[120:123], v[124:127], v[72:75]
    v_mfma_f32_16x16x32_bf16 v[76:79], a[124:127], v[124:127], v[76:79]
    s_cbranch_vccnz L_ofchk8_46_r
L_ofok8_47:
    s_waitcnt vmcnt(8)
    v_max3_u32 v31, v132, v133, v134
    v_max_u32 v31, v31, v135
    v_cmp_eq_u32 vcc, -1, v31
    v_mfma_f32_16x16x32_bf16 v[64:67], a[128:131], v[128:131], v[64:67]
    v_mfma_f32_16x16x32_bf16 v[68:71], a[132:135], v[128:131], v[68:71]
    v_mfma_f32_16x16x32_bf16 v[72:75], a[136:139], v[128:131], v[72:75]
    v_mfma_f32_16x16x32_bf16 v[76:79], a[140:143], v[128:131], v[76:79]
    s_cbranch_vccnz L_ofchk9_48_r
L_ofok9_49:
    s_waitcnt vmcnt(7)
    v_max3_u32 v31, v136, v137, v138
    v_max_u32 v31, v31, v139
    v_cmp_eq_u32 vcc, -1, v31
    v_mfma_f32_16x16x32_bf16 v[64:67], a[144:147], v[132:135], v[64:67]
    v_mfma_f32_16x16x32_bf16 v[68:71], a[148:151], v[132:135], v[68:71]
    v_mfma_f32_16x16x32_bf16 v[72:75], a[152:155], v[132:135], v[72:75]
    v_mfma_f32_16x16x32_bf16 v[76:79], a[156:159], v[132:135], v[76:79]
    s_cbranch_vccnz L_ofchk10_50_r
L_ofok10_51:
    s_waitcnt vmcnt(6)
    v_max3_u32 v31, v140, v141, v142
    v_max_u32 v31, v31, v143
    v_cmp_eq_u32 vcc, -1, v31
    v_mfma_f32_16x16x32_bf16 v[64:67], a[160:163], v[136:139], v[64:67]
    v_mfma_f32_16x16x32_bf16 v[68:71], a[164:167], v[136:139], v[68:71]
    v_mfma_f32_16x16x32_bf16 v[72:75], a[168:171], v[136:139], v[72:75]
    v_mfma_f32_16x16x32_bf16 v[76:79], a[172:175], v[136:139], v[76:79]
    s_cbranch_vccnz L_ofchk11_52_r
L_ofok11_53:
    s_waitcnt vmcnt(5)
    v_max3_u32 v31, v144, v145, v146
    v_max_u32 v31, v31, v147
    v_cmp_eq_u32 vcc, -1, v31
    v_mfma_f32_16x16x32_bf16 v[64:67], a[176:179], v[140:143], v[64:67]
    v_mfma_f32_16x16x32_bf16 v[68:71], a[180:183], v[140:143], v[68:71]
    v_mfma_f32_16x16x32_bf16 v[72:75], a[184:187], v[140:143], v[72:75]
    v_mfma_f32_16x16x32_bf16 v[76:79], a[188:191], v[140:143], v[76:79]
    s_cbranch_vccnz L_ofchk12_54_r
L_ofok12_55:
    s_waitcnt vmcnt(4)
    v_max3_u32 v31, v148, v149, v150
    v_max_u32 v31, v31, v151
    v_cmp_eq_u32 vcc, -1, v31
    v_mfma_f32_16x16x32_bf16 v[64:67], a[192:195], v[144:147], v[64:67]
    v_mfma_f32_16x16x32_bf16 v[68:71], a[196:199], v[144:147], v[68:71]
    v_mfma_f32_16x16x32_bf16 v[72:75], a[200:203], v[144:147], v[72:75]
    v_mfma_f32_16x16x32_bf16 v[76:79], a[204:207], v[144:147], v[76:79]
    s_cbranch_vccnz L_ofchk13_56_r
L_ofok13_57:
    s_waitcnt vmcnt(3)
    v_max3_u32 v31, v152, v153, v154
    v_max_u32 v31, v31, v155
    v_cmp_eq_u32 vcc, -1, v31
    v_mfma_f32_16x16x32_bf16 v[64:67], a[208:211], v[148:151], v[64:67]
    v_mfma_f32_16x16x32_bf16 v[68:71], a[212:215], v[148:151], v[68:71]
    v_mfma_f32_16x16x32_bf16 v[72:75], a[216:219], v[148:151], v[72:75]
    v_mfma_f32_16x16x32_bf16 v[76:79], a[220:223], v[148:151], v[76:79]
    s_cbranch_vccnz L_ofchk14_58_r
L_ofok14_59:
    s_waitcnt vmcnt(2)
    v_max3_u32 v31, v156, v157, v158
    v_max_u32 v31, v31, v159
    v_cmp_eq_u32 vcc, -1, v31
    v_mfma_f32_16x16x32_bf16 v[64:67], a[224:227], v[152:155], v[64:67]
    v_mfma_f32_16x16x32_bf16 v[68:71], a[228:231], v[152:155], v[68:71]
    v_mfma_f32_16x16x32_bf16 v[72:75], a[232:235], v[152:155], v[72:75]
    v_mfma_f32_16x16x32_bf16 v[76:79], a[236:239], v[152:155], v[76:79]
    s_cbranch_vccnz L_ofchk15_60_r
L_ofok15_61:
    v_mfma_f32_16x16x32_bf16 v[64:67], a[240:243], v[156:159], v[64:67]
    v_mfma_f32_16x16x32_bf16 v[68:71], a[244:247], v[156:159], v[68:71]
    v_mfma_f32_16x16x32_bf16 v[72:75], a[248:251], v[156:159], v[72:75]
    v_mfma_f32_16x16x32_bf16 v[76:79], a[252:255], v[156:159], v[76:79]
    s_nop 7
    v_cvt_pk_bf16_f32 v88, v64, v65
    v_cvt_pk_bf16_f32 v89, v66, v67
    v_cvt_pk_bf16_f32 v90, v68, v69
    v_cvt_pk_bf16_f32 v91, v70, v71
    v_cvt_pk_bf16_f32 v92, v72, v73
    v_cvt_pk_bf16_f32 v93, v74, v75
    v_cvt_pk_bf16_f32 v94, v76, v77
    v_cvt_pk_bf16_f32 v95, v78, v79
    s_nop 1
    v_permlane16_swap_b32 v88, v90
    v_permlane16_swap_b32 v89, v91
    v_permlane16_swap_b32 v92, v94
    v_permlane16_swap_b32 v93, v95
    s_nop 1
    buffer_store_dwordx4 v[88:91], v30, s[36:39], s60 offen
    buffer_store_dwordx4 v[92:95], v30, s[36:39], s60 offen offset:64
L_end:
    s_endpgm
L_nonce_poll_3:
    s_mov_b32 s55, 0
L_nonce_poll_3_l:
    v_mov_b32 v3, 0
    buffer_load_dwordx2 v[8:9], v3, s[44:47], 0 offen sc1
    s_waitcnt vmcnt(0)
    v_readfirstlane_b32 s52, v8
    v_readfirstlane_b32 s53, v9
    s_add_u32 s55, s55, 1
    s_cmp_gt_u32 s55, 0x20000
    s_cbranch_scc1 L_nonce_ok_2
    s_cmp_eq_u32 s53, 0
    s_cbranch_scc1 L_nonce_poll_3_l
    s_branch L_nonce_ok_2
L_u_slow_4:
    s_mov_b32 s55, 0
    s_branch L_f1_chk_8
L_f1_6:
    s_sleep 2
    buffer_load_dwordx2 v[4:5], v7, s[40:43], s20 offen sc1
    s_waitcnt vmcnt(0)
L_f1_chk_8:
    s_add_u32 s55, s55, 1
    v_cmp_ne_u64 vcc, s[52:53], v[4:5]
    s_nop 0
    s_and_b32 vcc_lo, vcc_lo, -1
    s_cbranch_scc0 L_f1_done_7
    s_cmp_lt_u32 s55, 0x20000
    s_cbranch_scc1 L_f1_6
L_f1_done_7:
    buffer_load_dwordx4 v[16:19], v13, s[40:43], s67 offen sc1
    buffer_load_dwordx4 v[20:23], v13, s[40:43], s67 offen offset:2048 sc1
    s_waitcnt vmcnt(0)
    s_branch L_u_back_5
L_attn_j0_18:
    s_waitcnt vmcnt(0)
    buffer_store_dwordx2 v[8:9], v10, s[40:43], s19 offen sc1
    s_branch L_attn_done_15
L_attn_fallback_16:
    s_mov_b32 s84, 0xf149f2ca
    v_sub_f32 v128, s84, v144
    v_sub_f32 v129, s84, v145
    v_sub_f32 v130, s84, v146
    v_sub_f32 v131, s84, v147
    v_sub_f32 v132, s84, v148
    v_sub_f32 v133, s84, v149
    v_sub_f32 v134, s84, v150
    v_sub_f32 v135, s84, v151
    v_sub_f32 v136, s84, v152
    v_sub_f32 v137, s84, v153
    v_sub_f32 v138, s84, v154
    v_sub_f32 v139, s84, v155
    v_sub_f32 v140, s84, v156
    v_sub_f32 v141, s84, v157
    v_sub_f32 v142, s84, v158
    v_sub_f32 v143, s84, v159
    v_mov_b32 v2, s84
    v_mov_b32 v3, s84
    s_waitcnt vmcnt(0)
    v_mfma_f32_32x32x16_bf16 v[16:31], v[236:239], v[228:231], v[144:159]
    s_nop 7
    s_nop 3
    v_max3_f32 v3, v3, v16, v17
    v_max3_f32 v3, v3, v18, v19
    v_max3_f32 v3, v3, v20, v21
    v_max3_f32 v3, v3, v22, v23
    v_max3_f32 v3, v3, v24, v25
    v_max3_f32 v3, v3, v26, v27
    v_max3_f32 v3, v3, v28, v29
    v_max3_f32 v3, v3, v30, v31
    s_nop 7
    v_mfma_f32_32x32x16_bf16 v[16:31], v[232:235], v[224:227], v[144:159]
    s_nop 7
    s_nop 3
    v_max3_f32 v2, v2, v16, v17
    v_max3_f32 v2, v2, v18, v19
    v_max3_f32 v2, v2, v20, v21
    v_max3_f32 v2, v2, v22, v23
    v_max3_f32 v2, v2, v24, v25
    v_max3_f32 v2, v2, v26, v27
    v_max3_f32 v2, v2, v28, v29
    v_max3_f32 v2, v2, v30, v31
    s_nop 7
    v_mfma_f32_32x32x16_bf16 v[16:31], v[232:235], v[228:231], 0
    s_nop 7
    s_nop 3
    v_max3_f32 v3, v3, v16, v17
    v_max3_f32 v3, v3, v18, v19
    v_max3_f32 v3, v3, v20, v21
    v_max3_f32 v3, v3, v22, v23
    v_max3_f32 v3, v3, v24, v25
    v_max3_f32 v3, v3, v26, v27
    v_max3_f32 v3, v3, v28, v29
    v_max3_f32 v3, v3, v30, v31
    s_nop 7
    s_cmp_le_u32 s83, 0
    s_cbranch_scc1 L_fb_done_19
    v_mfma_f32_32x32x16_bf16 v[16:31], a[28:31], v[224:227], 0
    s_nop 7
    s_nop 3
    v_max3_f32 v2, v2, v16, v17
    v_max3_f32 v2, v2, v18, v19
    v_max3_f32 v2, v2, v20, v21
    v_max3_f32 v2, v2, v22, v23
    v_max3_f32 v2, v2, v24, v25
    v_max3_f32 v2, v2, v26, v27
    v_max3_f32 v2, v2, v28, v29
    v_max3_f32 v2, v2, v30, v31
    s_nop 7
    v_mfma_f32_32x32x16_bf16 v[16:31], a[28:31], v[228:231], 0
    s_nop 7
    s_nop 3
    v_max3_f32 v3, v3, v16, v17
    v_max3_f32 v3, v3, v18, v19
    v_max3_f32 v3, v3, v20, v21
    v_max3_f32 v3, v3, v22, v23
    v_max3_f32 v3, v3, v24, v25
    v_max3_f32 v3, v3, v26, v27
    v_max3_f32 v3, v3, v28, v29
    v_max3_f32 v3, v3, v30, v31
    s_nop 7
    v_mfma_f32_32x32x16_bf16 v[16:31], a[24:27], v[224:227], 0
    s_nop 7
    s_nop 3
    v_max3_f32 v2, v2, v16, v17
    v_max3_f32 v2, v2, v18, v19
    v_max3_f32 v2, v2, v20, v21
    v_max3_f32 v2, v2, v22, v23
    v_max3_f32 v2, v2, v24, v25
    v_max3_f32 v2, v2, v26, v27
    v_max3_f32 v2, v2, v28, v29
    v_max3_f32 v2, v2, v30, v31
    s_nop 7
    v_mfma_f32_32x32x16_bf16 v[16:31], a[24:27], v[228:231], 0
    s_nop 7
    s_nop 3
    v_max3_f32 v3, v3, v16, v17
    v_max3_f32 v3, v3, v18, v19
    v_max3_f32 v3, v3, v20, v21
    v_max3_f32 v3, v3, v22, v23
    v_max3_f32 v3, v3, v24, v25
    v_max3_f32 v3, v3, v26, v27
    v_max3_f32 v3, v3, v28, v29
    v_max3_f32 v3, v3, v30, v31
    s_nop 7
    s_cmp_le_u32 s83, 1
    s_cbranch_scc1 L_fb_done_19
    v_mfma_f32_32x32x16_bf16 v[16:31], a[20:23], v[224:227], 0
    s_nop 7
    s_nop 3
    v_max3_f32 v2, v2, v16, v17
    v_max3_f32 v2, v2, v18, v19
    v_max3_f32 v2, v2, v20, v21
    v_max3_f32 v2, v2, v22, v23
    v_max3_f32 v2, v2, v24, v25
    v_max3_f32 v2, v2, v26, v27
    v_max3_f32 v2, v2, v28, v29
    v_max3_f32 v2, v2, v30, v31
    s_nop 7
    v_mfma_f32_32x32x16_bf16 v[16:31], a[20:23], v[228:231], 0
    s_nop 7
    s_nop 3
    v_max3_f32 v3, v3, v16, v17
    v_max3_f32 v3, v3, v18, v19
    v_max3_f32 v3, v3, v20, v21
    v_max3_f32 v3, v3, v22, v23
    v_max3_f32 v3, v3, v24, v25
    v_max3_f32 v3, v3, v26, v27
    v_max3_f32 v3, v3, v28, v29
    v_max3_f32 v3, v3, v30, v31
    s_nop 7
    v_mfma_f32_32x32x16_bf16 v[16:31], a[16:19], v[224:227], 0
    s_nop 7
    s_nop 3
    v_max3_f32 v2, v2, v16, v17
    v_max3_f32 v2, v2, v18, v19
    v_max3_f32 v2, v2, v20, v21
    v_max3_f32 v2, v2, v22, v23
    v_max3_f32 v2, v2, v24, v25
    v_max3_f32 v2, v2, v26, v27
    v_max3_f32 v2, v2, v28, v29
    v_max3_f32 v2, v2, v30, v31
    s_nop 7
    v_mfma_f32_32x32x16_bf16 v[16:31], a[16:19], v[228:231], 0
    s_nop 7
    s_nop 3
    v_max3_f32 v3, v3, v16, v17
    v_max3_f32 v3, v3, v18, v19
    v_max3_f32 v3, v3, v20, v21
    v_max3_f32 v3, v3, v22, v23
    v_max3_f32 v3, v3, v24, v25
    v_max3_f32 v3, v3, v26, v27
    v_max3_f32 v3, v3, v28, v29
    v_max3_f32 v3, v3, v30, v31
    s_nop 7
    s_cmp_le_u32 s83, 2
    s_cbranch_scc1 L_fb_done_19
    v_mfma_f32_32x32x16_bf16 v[16:31], a[12:15], v[224:227], 0
    s_nop 7
    s_nop 3
    v_max3_f32 v2, v2, v16, v17
    v_max3_f32 v2, v2, v18, v19
    v_max3_f32 v2, v2, v20, v21
    v_max3_f32 v2, v2, v22, v23
    v_max3_f32 v2, v2, v24, v25
    v_max3_f32 v2, v2, v26, v27
    v_max3_f32 v2, v2, v28, v29
    v_max3_f32 v2, v2, v30, v31
    s_nop 7
    v_mfma_f32_32x32x16_bf16 v[16:31], a[12:15], v[228:231], 0
    s_nop 7
    s_nop 3
    v_max3_f32 v3, v3, v16, v17
    v_max3_f32 v3, v3, v18, v19
    v_max3_f32 v3, v3, v20, v21
    v_max3_f32 v3, v3, v22, v23
    v_max3_f32 v3, v3, v24, v25
    v_max3_f32 v3, v3, v26, v27
    v_max3_f32 v3, v3, v28, v29
    v_max3_f32 v3, v3, v30, v31
    s_nop 7
    v_mfma_f32_32x32x16_bf16 v[16:31], a[8:11], v[224:227], 0
    s_nop 7
    s_nop 3
    v_max3_f32 v2, v2, v16, v17
    v_max3_f32 v2, v2, v18, v19
    v_max3_f32 v2, v2, v20, v21
    v_max3_f32 v2, v2, v22, v23
    v_max3_f32 v2, v2, v24, v25
    v_max3_f32 v2, v2, v26, v27
    v_max3_f32 v2, v2, v28, v29
    v_max3_f32 v2, v2, v30, v31
    s_nop 7
    v_mfma_f32_32x32x16_bf16 v[16:31], a[8:11], v[228:231], 0
    s_nop 7
    s_nop 3
    v_max3_f32 v3, v3, v16, v17
    v_max3_f32 v3, v3, v18, v19
    v_max3_f32 v3, v3, v20, v21
    v_max3_f32 v3, v3, v22, v23
    v_max3_f32 v3, v3, v24, v25
    v_max3_f32 v3, v3, v26, v27
    v_max3_f32 v3, v3, v28, v29
    v_max3_f32 v3, v3, v30, v31
    s_nop 7
    s_cmp_le_u32 s83, 3
    s_cbranch_scc1 L_fb_done_19
    v_mfma_f32_32x32x16_bf16 v[16:31], a[4:7], v[224:227], 0
    s_nop 7
    s_nop 3
    v_max3_f32 v2, v2, v16, v17
    v_max3_f32 v2, v2, v18, v19
    v_max3_f32 v2, v2, v20, v21
    v_max3_f32 v2, v2, v22, v23
    v_max3_f32 v2, v2, v24, v25
    v_max3_f32 v2, v2, v26, v27
    v_max3_f32 v2, v2, v28, v29
    v_max3_f32 v2, v2, v30, v31
    s_nop 7
    v_mfma_f32_32x32x16_bf16 v[16:31], a[4:7], v[228:231], v[128:143]
    s_nop 7
    s_nop 3
    v_max3_f32 v3, v3, v16, v17
    v_max3_f32 v3, v3, v18, v19
    v_max3_f32 v3, v3, v20, v21
    v_max3_f32 v3, v3, v22, v23
    v_max3_f32 v3, v3, v24, v25
    v_max3_f32 v3, v3, v26, v27
    v_max3_f32 v3, v3, v28, v29
    v_max3_f32 v3, v3, v30, v31
    s_nop 7
    v_mfma_f32_32x32x16_bf16 v[16:31], a[0:3], v[224:227], v[128:143]
    s_nop 7
    s_nop 3
    v_max3_f32 v2, v2, v16, v17
    v_max3_f32 v2, v2, v18, v19
    v_max3_f32 v2, v2, v20, v21
    v_max3_f32 v2, v2, v22, v23
    v_max3_f32 v2, v2, v24, v25
    v_max3_f32 v2, v2, v26, v27
    v_max3_f32 v2, v2, v28, v29
    v_max3_f32 v2, v2, v30, v31
    s_nop 7
L_fb_done_19:
    v_mov_b32 v4, v2
    s_nop 1
    v_permlane32_swap_b32 v2, v4
    s_nop 1
    v_max_f32 v2, v2, v4
    v_sub_f32 v2, 0, v2
    v_mov_b32 v184, v2
    v_mov_b32 v185, v2
    v_mov_b32 v186, v2
    v_mov_b32 v187, v2
    v_mov_b32 v188, v2
    v_mov_b32 v189, v2
    v_mov_b32 v190, v2
    v_mov_b32 v191, v2
    v_mov_b32 v192, v2
    v_mov_b32 v193, v2
    v_mov_b32 v194, v2
    v_mov_b32 v195, v2
    v_mov_b32 v196, v2
    v_mov_b32 v197, v2
    v_mov_b32 v198, v2
    v_mov_b32 v199, v2
    v_mov_b32 v4, v3
    s_nop 1
    v_permlane32_swap_b32 v3, v4
    s_nop 1
    v_max_f32 v3, v3, v4
    v_sub_f32 v3, 0, v3
    v_mov_b32 v160, v3
    v_mov_b32 v161, v3
    v_mov_b32 v162, v3
    v_mov_b32 v163, v3
    v_mov_b32 v164, v3
    v_mov_b32 v165, v3
    v_mov_b32 v166, v3
    v_mov_b32 v167, v3
    v_mov_b32 v168, v3
    v_mov_b32 v169, v3
    v_mov_b32 v170, v3
    v_mov_b32 v171, v3
    v_mov_b32 v172, v3
    v_mov_b32 v173, v3
    v_mov_b32 v174, v3
    v_mov_b32 v175, v3
    s_mov_b32 s94, 1
    s_branch L_attn_main_14
L_ofchk0_30_r:
    s_call_b64 s[30:31], L_of_reload0_26
    s_cbranch_scc1 L_ofok0_31
    v_max3_u32 v31, v96, v97, v98
    v_max_u32 v31, v31, v99
    v_cmp_eq_u32 vcc, -1, v31
    s_nop 3
    s_cbranch_vccnz L_ofchk0_30_r
    s_branch L_ofok0_31
L_ofchk1_32_r:
    s_call_b64 s[30:31], L_of_reload0_26
    s_cbranch_scc1 L_ofok1_33
    v_max3_u32 v31, v100, v101, v102
    v_max_u32 v31, v31, v103
    v_cmp_eq_u32 vcc, -1, v31
    s_nop 3
    s_cbranch_vccnz L_ofchk1_32_r
    s_branch L_ofok1_33
L_ofchk2_34_r:
    s_call_b64 s[30:31], L_of_reload0_26
    s_cbranch_scc1 L_ofok2_35
    v_max3_u32 v31, v104, v105, v106
    v_max_u32 v31, v31, v107
    v_cmp_eq_u32 vcc, -1, v31
    s_nop 3
    s_cbranch_vccnz L_ofchk2_34_r
    s_branch L_ofok2_35
L_ofchk3_36_r:
    s_call_b64 s[30:31], L_of_reload0_26
    s_cbranch_scc1 L_ofok3_37
    v_max3_u32 v31, v108, v109, v110
    v_max_u32 v31, v31, v111
    v_cmp_eq_u32 vcc, -1, v31
    s_nop 3
    s_cbranch_vccnz L_ofchk3_36_r
    s_branch L_ofok3_37
L_ofchk4_38_r:
    s_call_b64 s[30:31], L_of_reload1_27
    s_cbranch_scc1 L_ofok4_39
    v_max3_u32 v31, v112, v113, v114
    v_max_u32 v31, v31, v115
    v_cmp_eq_u32 vcc, -1, v31
    s_nop 3
    s_cbranch_vccnz L_ofchk4_38_r
    s_branch L_ofok4_39
L_ofchk5_40_r:
    s_call_b64 s[30:31], L_of_reload1_27
    s_cbranch_scc1 L_ofok5_41
    v_max3_u32 v31, v116, v117, v118
    v_max_u32 v31, v31, v119
    v_cmp_eq_u32 vcc, -1, v31
    s_nop 3
    s_cbranch_vccnz L_ofchk5_40_r
    s_branch L_ofok5_41
L_ofchk6_42_r:
    s_call_b64 s[30:31], L_of_reload1_27
    s_cbranch_scc1 L_ofok6_43
    v_max3_u32 v31, v120, v121, v122
    v_max_u32 v31, v31, v123
    v_cmp_eq_u32 vcc, -1, v31
    s_nop 3
    s_cbranch_vccnz L_ofchk6_42_r
    s_branch L_ofok6_43
L_ofchk7_44_r:
    s_call_b64 s[30:31], L_of_reload1_27
    s_cbranch_scc1 L_ofok7_45
    v_max3_u32 v31, v124, v125, v126
    v_max_u32 v31, v31, v127
    v_cmp_eq_u32 vcc, -1, v31
    s_nop 3
    s_cbranch_vccnz L_ofchk7_44_r
    s_branch L_ofok7_45
L_ofchk8_46_r:
    s_call_b64 s[30:31], L_of_reload2_28
    s_cbranch_scc1 L_ofok8_47
    v_max3_u32 v31, v128, v129, v130
    v_max_u32 v31, v31, v131
    v_cmp_eq_u32 vcc, -1, v31
    s_nop 3
    s_cbranch_vccnz L_ofchk8_46_r
    s_branch L_ofok8_47
L_ofchk9_48_r:
    s_call_b64 s[30:31], L_of_reload2_28
    s_cbranch_scc1 L_ofok9_49
    v_max3_u32 v31, v132, v133, v134
    v_max_u32 v31, v31, v135
    v_cmp_eq_u32 vcc, -1, v31
    s_nop 3
    s_cbranch_vccnz L_ofchk9_48_r
    s_branch L_ofok9_49
L_ofchk10_50_r:
    s_call_b64 s[30:31], L_of_reload2_28
    s_cbranch_scc1 L_ofok10_51
    v_max3_u32 v31, v136, v137, v138
    v_max_u32 v31, v31, v139
    v_cmp_eq_u32 vcc, -1, v31
    s_nop 3
    s_cbranch_vccnz L_ofchk10_50_r
    s_branch L_ofok10_51
L_ofchk11_52_r:
    s_call_b64 s[30:31], L_of_reload2_28
    s_cbranch_scc1 L_ofok11_53
    v_max3_u32 v31, v140, v141, v142
    v_max_u32 v31, v31, v143
    v_cmp_eq_u32 vcc, -1, v31
    s_nop 3
    s_cbranch_vccnz L_ofchk11_52_r
    s_branch L_ofok11_53
L_ofchk12_54_r:
    s_call_b64 s[30:31], L_of_reload3_29
    s_cbranch_scc1 L_ofok12_55
    v_max3_u32 v31, v144, v145, v146
    v_max_u32 v31, v31, v147
    v_cmp_eq_u32 vcc, -1, v31
    s_nop 3
    s_cbranch_vccnz L_ofchk12_54_r
    s_branch L_ofok12_55
L_ofchk13_56_r:
    s_call_b64 s[30:31], L_of_reload3_29
    s_cbranch_scc1 L_ofok13_57
    v_max3_u32 v31, v148, v149, v150
    v_max_u32 v31, v31, v151
    v_cmp_eq_u32 vcc, -1, v31
    s_nop 3
    s_cbranch_vccnz L_ofchk13_56_r
    s_branch L_ofok13_57
L_ofchk14_58_r:
    s_call_b64 s[30:31], L_of_reload3_29
    s_cbranch_scc1 L_ofok14_59
    v_max3_u32 v31, v152, v153, v154
    v_max_u32 v31, v31, v155
    v_cmp_eq_u32 vcc, -1, v31
    s_nop 3
    s_cbranch_vccnz L_ofchk14_58_r
    s_branch L_ofok14_59
L_ofchk15_60_r:
    s_call_b64 s[30:31], L_of_reload3_29
    s_cbranch_scc1 L_ofok15_61
    v_max3_u32 v31, v156, v157, v158
    v_max_u32 v31, v31, v159
    v_cmp_eq_u32 vcc, -1, v31
    s_nop 3
    s_cbranch_vccnz L_ofchk15_60_r
    s_branch L_ofok15_61
L_of_reload0_26:
    s_sleep 2
    s_add_u32 s90, s61, 0
    buffer_load_dwordx4 v[96:99], v13, s[40:43], s90 offen offset:0 sc1
    buffer_load_dwordx4 v[100:103], v13, s[40:43], s90 offen offset:1024 sc1
    buffer_load_dwordx4 v[104:107], v13, s[40:43], s90 offen offset:2048 sc1
    buffer_load_dwordx4 v[108:111], v13, s[40:43], s90 offen offset:3072 sc1
    s_add_u32 s90, s61, 4096
    buffer_load_dwordx4 v[112:115], v13, s[40:43], s90 offen offset:0 sc1
    buffer_load_dwordx4 v[116:119], v13, s[40:43], s90 offen offset:1024 sc1
    buffer_load_dwordx4 v[120:123], v13, s[40:43], s90 offen offset:2048 sc1
    buffer_load_dwordx4 v[124:127], v13, s[40:43], s90 offen offset:3072 sc1
    s_add_u32 s90, s61, 8192
    buffer_load_dwordx4 v[128:131], v13, s[40:43], s90 offen offset:0 sc1
    buffer_load_dwordx4 v[132:135], v13, s[40:43], s90 offen offset:1024 sc1
    buffer_load_dwordx4 v[136:139], v13, s[40:43], s90 offen offset:2048 sc1
    buffer_load_dwordx4 v[140:143], v13, s[40:43], s90 offen offset:3072 sc1
    s_add_u32 s90, s61, 12288
    buffer_load_dwordx4 v[144:147], v13, s[40:43], s90 offen offset:0 sc1
    buffer_load_dwordx4 v[148:151], v13, s[40:43], s90 offen offset:1024 sc1
    buffer_load_dwordx4 v[152:155], v13, s[40:43], s90 offen offset:2048 sc1
    buffer_load_dwordx4 v[156:159], v13, s[40:43], s90 offen offset:3072 sc1
    s_waitcnt vmcnt(0)
    s_add_u32 s55, s55, 1
    s_cmp_gt_u32 s55, 0x8000
    s_setpc_b64 s[30:31]
L_of_reload1_27:
    s_sleep 2
    s_add_u32 s90, s61, 4096
    buffer_load_dwordx4 v[112:115], v13, s[40:43], s90 offen offset:0 sc1
    buffer_load_dwordx4 v[116:119], v13, s[40:43], s90 offen offset:1024 sc1
    buffer_load_dwordx4 v[120:123], v13, s[40:43], s90 offen offset:2048 sc1
    buffer_load_dwordx4 v[124:127], v13, s[40:43], s90 offen offset:3072 sc1
    s_add_u32 s90, s61, 8192
    buffer_load_dwordx4 v[128:131], v13, s[40:43], s90 offen offset:0 sc1
    buffer_load_dwordx4 v[132:135], v13, s[40:43], s90 offen offset:1024 sc1
    buffer_load_dwordx4 v[136:139], v13, s[40:43], s90 offen offset:2048 sc1
    buffer_load_dwordx4 v[140:143], v13, s[40:43], s90 offen offset:3072 sc1
    s_add_u32 s90, s61, 12288
    buffer_load_dwordx4 v[144:147], v13, s[40:43], s90 offen offset:0 sc1
    buffer_load_dwordx4 v[148:151], v13, s[40:43], s90 offen offset:1024 sc1
    buffer_load_dwordx4 v[152:155], v13, s[40:43], s90 offen offset:2048 sc1
    buffer_load_dwordx4 v[156:159], v13, s[40:43], s90 offen offset:3072 sc1
    s_waitcnt vmcnt(0)
    s_add_u32 s55, s55, 1
    s_cmp_gt_u32 s55, 0x8000
    s_setpc_b64 s[30:31]
L_of_reload2_28:
    s_sleep 2
    s_add_u32 s90, s61, 8192
    buffer_load_dwordx4 v[128:131], v13, s[40:43], s90 offen offset:0 sc1
    buffer_load_dwordx4 v[132:135], v13, s[40:43], s90 offen offset:1024 sc1
    buffer_load_dwordx4 v[136:139], v13, s[40:43], s90 offen offset:2048 sc1
    buffer_load_dwordx4 v[140:143], v13, s[40:43], s90 offen offset:3072 sc1
    s_add_u32 s90, s61, 12288
    buffer_load_dwordx4 v[144:147], v13, s[40:43], s90 offen offset:0 sc1
    buffer_load_dwordx4 v[148:151], v13, s[40:43], s90 offen offset:1024 sc1
    buffer_load_dwordx4 v[152:155], v13, s[40:43], s90 offen offset:2048 sc1
    buffer_load_dwordx4 v[156:159], v13, s[40:43], s90 offen offset:3072 sc1
    s_waitcnt vmcnt(0)
    s_add_u32 s55, s55, 1
    s_cmp_gt_u32 s55, 0x8000
    s_setpc_b64 s[30:31]
L_of_reload3_29:
    s_sleep 2
    s_add_u32 s90, s61, 12288
    buffer_load_dwordx4 v[144:147], v13, s[40:43], s90 offen offset:0 sc1
    buffer_load_dwordx4 v[148:151], v13, s[40:43], s90 offen offset:1024 sc1
    buffer_load_dwordx4 v[152:155], v13, s[40:43], s90 offen offset:2048 sc1
    buffer_load_dwordx4 v[156:159], v13, s[40:43], s90 offen offset:3072 sc1
    s_waitcnt vmcnt(0)
    s_add_u32 s55, s55, 1
    s_cmp_gt_u32 s55, 0x8000
    s_setpc_b64 s[30:31]
.p2align 6
L_masktab:
.long 0x0, 0xf149f2ca, 0xf149f2ca, 0xf149f2ca
.long 0x0, 0x0, 0xf149f2ca, 0xf149f2ca
.long 0x0, 0x0, 0x0, 0xf149f2ca
.long 0x0, 0x0, 0x0, 0x0
.long 0x0, 0x0, 0x0, 0x0
.long 0x0, 0x0, 0x0, 0x0
.long 0x0, 0x0, 0x0, 0x0
.long 0x0, 0x0, 0x0, 0x0
.long 0x0, 0x0, 0x0, 0x0
.long 0x0, 0x0, 0x0, 0x0
.long 0x0, 0x0, 0x0, 0x0
.long 0x0, 0x0, 0x0, 0x0
.long 0x0, 0x0, 0x0, 0x0
.long 0x0, 0x0, 0x0, 0x0
.long 0x0, 0x0, 0x0, 0x0
.long 0x0, 0x0, 0x0, 0x0
.long 0x0, 0x0, 0x0, 0x0
.long 0x0, 0x0, 0x0, 0x0
.long 0x0, 0x0, 0x0, 0x0
.long 0x0, 0x0, 0x0, 0x0
.long 0x0, 0x0, 0x0, 0x0
.long 0x0, 0x0, 0x0, 0x0
.long 0x0, 0x0, 0x0, 0x0
.long 0x0, 0x0, 0x0, 0x0
.long 0x0, 0x0, 0x0, 0x0
.long 0x0, 0x0, 0x0, 0x0
.long 0x0, 0x0, 0x0, 0x0
.long 0x0, 0x0, 0x0, 0x0
.long 0x0, 0x0, 0x0, 0x0
.long 0x0, 0x0, 0x0, 0x0
.long 0x0, 0x0, 0x0, 0x0
.long 0x0, 0x0, 0x0, 0x0
.long 0xf149f2ca, 0xf149f2ca, 0xf149f2ca, 0xf149f2ca
.long 0xf149f2ca, 0xf149f2ca, 0xf149f2ca, 0xf149f2ca
.long 0xf149f2ca, 0xf149f2ca, 0xf149f2ca, 0xf149f2ca
.long 0xf149f2ca, 0xf149f2ca, 0xf149f2ca, 0xf149f2ca
.long 0x0, 0xf149f2ca, 0xf149f2ca, 0xf149f2ca
.long 0x0, 0x0, 0xf149f2ca, 0xf149f2ca
.long 0x0, 0x0, 0x0, 0xf149f2ca
.long 0x0, 0x0, 0x0, 0x0
.long 0x0, 0x0, 0x0, 0x0
.long 0x0, 0x0, 0x0, 0x0
.long 0x0, 0x0, 0x0, 0x0
.long 0x0, 0x0, 0x0, 0x0
.long 0x0, 0x0, 0x0, 0x0
.long 0x0, 0x0, 0x0, 0x0
.long 0x0, 0x0, 0x0, 0x0
.long 0x0, 0x0, 0x0, 0x0
.long 0x0, 0x0, 0x0, 0x0
.long 0x0, 0x0, 0x0, 0x0
.long 0x0, 0x0, 0x0, 0x0
.long 0x0, 0x0, 0x0, 0x0
.long 0x0, 0x0, 0x0, 0x0
.long 0x0, 0x0, 0x0, 0x0
.long 0x0, 0x0, 0x0, 0x0
.long 0x0, 0x0, 0x0, 0x0
.long 0x0, 0x0, 0x0, 0x0
.long 0x0, 0x0, 0x0, 0x0
.long 0x0, 0x0, 0x0, 0x0
.long 0x0, 0x0, 0x0, 0x0
.long 0x0, 0x0, 0x0, 0x0
.long 0x0, 0x0, 0x0, 0x0
.long 0x0, 0x0, 0x0, 0x0
.long 0x0, 0x0, 0x0, 0x0
.long 0xf149f2ca, 0xf149f2ca, 0xf149f2ca, 0xf149f2ca
.long 0xf149f2ca, 0xf149f2ca, 0xf149f2ca, 0xf149f2ca
.long 0xf149f2ca, 0xf149f2ca, 0xf149f2ca, 0xf149f2ca
.long 0xf149f2ca, 0xf149f2ca, 0xf149f2ca, 0xf149f2ca
.long 0xf149f2ca, 0xf149f2ca, 0xf149f2ca, 0xf149f2ca
.long 0xf149f2ca, 0xf149f2ca, 0xf149f2ca, 0xf149f2ca
.long 0xf149f2ca, 0xf149f2ca, 0xf149f2ca, 0xf149f2ca
.long 0xf149f2ca, 0xf149f2ca, 0xf149f2ca, 0xf149f2ca
.long 0x0, 0xf149f2ca, 0xf149f2ca, 0xf149f2ca
.long 0x0, 0x0, 0xf149f2ca, 0xf149f2ca
.long 0x0, 0x0, 0x0, 0xf149f2ca
.long 0x0, 0x0, 0x0, 0x0
.long 0x0, 0x0, 0x0, 0x0
.long 0x0, 0x0, 0x0, 0x0
.long 0x0, 0x0, 0x0, 0x0
.long 0x0, 0x0, 0x0, 0x0
.long 0x0, 0x0, 0x0, 0x0
.long 0x0, 0x0, 0x0, 0x0
.long 0x0, 0x0, 0x0, 0x0
.long 0x0, 0x0, 0x0, 0x0
.long 0x0, 0x0, 0x0, 0x0
.long 0x0, 0x0, 0x0, 0x0
.long 0x0, 0x0, 0x0, 0x0
.long 0x0, 0x0, 0x0, 0x0
.long 0x0, 0x0, 0x0, 0x0
.long 0x0, 0x0, 0x0, 0x0
.long 0x0, 0x0, 0x0, 0x0
.long 0x0, 0x0, 0x0, 0x0
.long 0x0, 0x0, 0x0, 0x0
.long 0x0, 0x0, 0x0, 0x0
.long 0x0, 0x0, 0x0, 0x0
.long 0x0, 0x0, 0x0, 0x0
.long 0xf149f2ca, 0xf149f2ca, 0xf149f2ca, 0xf149f2ca
.long 0xf149f2ca, 0xf149f2ca, 0xf149f2ca, 0xf149f2ca
.long 0xf149f2ca, 0xf149f2ca, 0xf149f2ca, 0xf149f2ca
.long 0xf149f2ca, 0xf149f2ca, 0xf149f2ca, 0xf149f2ca
.long 0xf149f2ca, 0xf149f2ca, 0xf149f2ca, 0xf149f2ca
.long 0xf149f2ca, 0xf149f2ca, 0xf149f2ca, 0xf149f2ca
.long 0xf149f2ca, 0xf149f2ca, 0xf149f2ca, 0xf149f2ca
.long 0xf149f2ca, 0xf149f2ca, 0xf149f2ca, 0xf149f2ca
.long 0xf149f2ca, 0xf149f2ca, 0xf149f2ca, 0xf149f2ca
.long 0xf149f2ca, 0xf149f2ca, 0xf149f2ca, 0xf149f2ca
.long 0xf149f2ca, 0xf149f2ca, 0xf149f2ca, 0xf149f2ca
.long 0xf149f2ca, 0xf149f2ca, 0xf149f2ca, 0xf149f2ca
.long 0x0, 0xf149f2ca, 0xf149f2ca, 0xf149f2ca
.long 0x0, 0x0, 0xf149f2ca, 0xf149f2ca
.long 0x0, 0x0, 0x0, 0xf149f2ca
.long 0x0, 0x0, 0x0, 0x0
.long 0x0, 0x0, 0x0, 0x0
.long 0x0, 0x0, 0x0, 0x0
.long 0x0, 0x0, 0x0, 0x0
.long 0x0, 0x0, 0x0, 0x0
.long 0x0, 0x0, 0x0, 0x0
.long 0x0, 0x0, 0x0, 0x0
.long 0x0, 0x0, 0x0, 0x0
.long 0x0, 0x0, 0x0, 0x0
.long 0x0, 0x0, 0x0, 0x0
.long 0x0, 0x0, 0x0, 0x0
.long 0x0, 0x0, 0x0, 0x0
.long 0x0, 0x0, 0x0, 0x0
.long 0x0, 0x0, 0x0, 0x0
.long 0x0, 0x0, 0x0, 0x0
.long 0x0, 0x0, 0x0, 0x0
.long 0x0, 0x0, 0x0, 0x0
.long 0xf149f2ca, 0xf149f2ca, 0xf149f2ca, 0xf149f2ca
.long 0xf149f2ca, 0xf149f2ca, 0xf149f2ca, 0xf149f2ca
.long 0xf149f2ca, 0xf149f2ca, 0xf149f2ca, 0xf149f2ca
.long 0xf149f2ca, 0xf149f2ca, 0xf149f2ca, 0xf149f2ca
.long 0xf149f2ca, 0xf149f2ca, 0xf149f2ca, 0xf149f2ca
.long 0xf149f2ca, 0xf149f2ca, 0xf149f2ca, 0xf149f2ca
.long 0xf149f2ca, 0xf149f2ca, 0xf149f2ca, 0xf149f2ca
.long 0xf149f2ca, 0xf149f2ca, 0xf149f2ca, 0xf149f2ca
.long 0xf149f2ca, 0xf149f2ca, 0xf149f2ca, 0xf149f2ca
.long 0xf149f2ca, 0xf149f2ca, 0xf149f2ca, 0xf149f2ca
.long 0xf149f2ca, 0xf149f2ca, 0xf149f2ca, 0xf149f2ca
.long 0xf149f2ca, 0xf149f2ca, 0xf149f2ca, 0xf149f2ca
.long 0xf149f2ca, 0xf149f2ca, 0xf149f2ca, 0xf149f2ca
.long 0xf149f2ca, 0xf149f2ca, 0xf149f2ca, 0xf149f2ca
.long 0xf149f2ca, 0xf149f2ca, 0xf149f2ca, 0xf149f2ca
.long 0xf149f2ca, 0xf149f2ca, 0xf149f2ca, 0xf149f2ca
.long 0x0, 0xf149f2ca, 0xf149f2ca, 0xf149f2ca
.long 0x0, 0x0, 0xf149f2ca, 0xf149f2ca
.long 0x0, 0x0, 0x0, 0xf149f2ca
.long 0x0, 0x0, 0x0, 0x0
.long 0x0, 0x0, 0x0, 0x0
.long 0x0, 0x0, 0x0, 0x0
.long 0x0, 0x0, 0x0, 0x0
.long 0x0, 0x0, 0x0, 0x0
.long 0x0, 0x0, 0x0, 0x0
.long 0x0, 0x0, 0x0, 0x0
.long 0x0, 0x0, 0x0, 0x0
.long 0x0, 0x0, 0x0, 0x0
.long 0x0, 0x0, 0x0, 0x0
.long 0x0, 0x0, 0x0, 0x0
.long 0x0, 0x0, 0x0, 0x0
.long 0x0, 0x0, 0x0, 0x0
.long 0xf149f2ca, 0xf149f2ca, 0xf149f2ca, 0xf149f2ca
.long 0xf149f2ca, 0xf149f2ca, 0xf149f2ca, 0xf149f2ca
.long 0xf149f2ca, 0xf149f2ca, 0xf149f2ca, 0xf149f2ca
.long 0xf149f2ca, 0xf149f2ca, 0xf149f2ca, 0xf149f2ca
.long 0xf149f2ca, 0xf149f2ca, 0xf149f2ca, 0xf149f2ca
.long 0xf149f2ca, 0xf149f2ca, 0xf149f2ca, 0xf149f2ca
.long 0xf149f2ca, 0xf149f2ca, 0xf149f2ca, 0xf149f2ca
.long 0xf149f2ca, 0xf149f2ca, 0xf149f2ca, 0xf149f2ca
.long 0xf149f2ca, 0xf149f2ca, 0xf149f2ca, 0xf149f2ca
.long 0xf149f2ca, 0xf149f2ca, 0xf149f2ca, 0xf149f2ca
.long 0xf149f2ca, 0xf149f2ca, 0xf149f2ca, 0xf149f2ca
.long 0xf149f2ca, 0xf149f2ca, 0xf149f2ca, 0xf149f2ca
.long 0xf149f2ca, 0xf149f2ca, 0xf149f2ca, 0xf149f2ca
.long 0xf149f2ca, 0xf149f2ca, 0xf149f2ca, 0xf149f2ca
.long 0xf149f2ca, 0xf149f2ca, 0xf149f2ca, 0xf149f2ca
.long 0xf149f2ca, 0xf149f2ca, 0xf149f2ca, 0xf149f2ca
.long 0xf149f2ca, 0xf149f2ca, 0xf149f2ca, 0xf149f2ca
.long 0xf149f2ca, 0xf149f2ca, 0xf149f2ca, 0xf149f2ca
.long 0xf149f2ca, 0xf149f2ca, 0xf149f2ca, 0xf149f2ca
.long 0xf149f2ca, 0xf149f2ca, 0xf149f2ca, 0xf149f2ca
.long 0x0, 0xf149f2ca, 0xf149f2ca, 0xf149f2ca
.long 0x0, 0x0, 0xf149f2ca, 0xf149f2ca
.long 0x0, 0x0, 0x0, 0xf149f2ca
.long 0x0, 0x0, 0x0, 0x0
.long 0x0, 0x0, 0x0, 0x0
.long 0x0, 0x0, 0x0, 0x0
.long 0x0, 0x0, 0x0, 0x0
.long 0x0, 0x0, 0x0, 0x0
.long 0x0, 0x0, 0x0, 0x0
.long 0x0, 0x0, 0x0, 0x0
.long 0x0, 0x0, 0x0, 0x0
.long 0x0, 0x0, 0x0, 0x0
.long 0xf149f2ca, 0xf149f2ca, 0xf149f2ca, 0xf149f2ca
.long 0xf149f2ca, 0xf149f2ca, 0xf149f2ca, 0xf149f2ca
.long 0xf149f2ca, 0xf149f2ca, 0xf149f2ca, 0xf149f2ca
.long 0xf149f2ca, 0xf149f2ca, 0xf149f2ca, 0xf149f2ca
.long 0xf149f2ca, 0xf149f2ca, 0xf149f2ca, 0xf149f2ca
.long 0xf149f2ca, 0xf149f2ca, 0xf149f2ca, 0xf149f2ca
.long 0xf149f2ca, 0xf149f2ca, 0xf149f2ca, 0xf149f2ca
.long 0xf149f2ca, 0xf149f2ca, 0xf149f2ca, 0xf149f2ca
.long 0xf149f2ca, 0xf149f2ca, 0xf149f2ca, 0xf149f2ca
.long 0xf149f2ca, 0xf149f2ca, 0xf149f2ca, 0xf149f2ca
.long 0xf149f2ca, 0xf149f2ca, 0xf149f2ca, 0xf149f2ca
.long 0xf149f2ca, 0xf149f2ca, 0xf149f2ca, 0xf149f2ca
.long 0xf149f2ca, 0xf149f2ca, 0xf149f2ca, 0xf149f2ca
.long 0xf149f2ca, 0xf149f2ca, 0xf149f2ca, 0xf149f2ca
.long 0xf149f2ca, 0xf149f2ca, 0xf149f2ca, 0xf149f2ca
.long 0xf149f2ca, 0xf149f2ca, 0xf149f2ca, 0xf149f2ca
.long 0xf149f2ca, 0xf149f2ca, 0xf149f2ca, 0xf149f2ca
.long 0xf149f2ca, 0xf149f2ca, 0xf149f2ca, 0xf149f2ca
.long 0xf149f2ca, 0xf149f2ca, 0xf149f2ca, 0xf149f2ca
.long 0xf149f2ca, 0xf149f2ca, 0xf149f2ca, 0xf149f2ca
.long 0xf149f2ca, 0xf149f2ca, 0xf149f2ca, 0xf149f2ca
.long 0xf149f2ca, 0xf149f2ca, 0xf149f2ca, 0xf149f2ca
.long 0xf149f2ca, 0xf149f2ca, 0xf149f2ca, 0xf149f2ca
.long 0xf149f2ca, 0xf149f2ca, 0xf149f2ca, 0xf149f2ca
.long 0x0, 0xf149f2ca, 0xf149f2ca, 0xf149f2ca
.long 0x0, 0x0, 0xf149f2ca, 0xf149f2ca
.long 0x0, 0x0, 0x0, 0xf149f2ca
.long 0x0, 0x0, 0x0, 0x0
.long 0x0, 0x0, 0x0, 0x0
.long 0x0, 0x0, 0x0, 0x0
.long 0x0, 0x0, 0x0, 0x0
.long 0x0, 0x0, 0x0, 0x0
.long 0xf149f2ca, 0xf149f2ca, 0xf149f2ca, 0xf149f2ca
.long 0xf149f2ca, 0xf149f2ca, 0xf149f2ca, 0xf149f2ca
.long 0xf149f2ca, 0xf149f2ca, 0xf149f2ca, 0xf149f2ca
.long 0xf149f2ca, 0xf149f2ca, 0xf149f2ca, 0xf149f2ca
.long 0xf149f2ca, 0xf149f2ca, 0xf149f2ca, 0xf149f2ca
.long 0xf149f2ca, 0xf149f2ca, 0xf149f2ca, 0xf149f2ca
.long 0xf149f2ca, 0xf149f2ca, 0xf149f2ca, 0xf149f2ca
.long 0xf149f2ca, 0xf149f2ca, 0xf149f2ca, 0xf149f2ca
.long 0xf149f2ca, 0xf149f2ca, 0xf149f2ca, 0xf149f2ca
.long 0xf149f2ca, 0xf149f2ca, 0xf149f2ca, 0xf149f2ca
.long 0xf149f2ca, 0xf149f2ca, 0xf149f2ca, 0xf149f2ca
.long 0xf149f2ca, 0xf149f2ca, 0xf149f2ca, 0xf149f2ca
.long 0xf149f2ca, 0xf149f2ca, 0xf149f2ca, 0xf149f2ca
.long 0xf149f2ca, 0xf149f2ca, 0xf149f2ca, 0xf149f2ca
.long 0xf149f2ca, 0xf149f2ca, 0xf149f2ca, 0xf149f2ca
.long 0xf149f2ca, 0xf149f2ca, 0xf149f2ca, 0xf149f2ca
.long 0xf149f2ca, 0xf149f2ca, 0xf149f2ca, 0xf149f2ca
.long 0xf149f2ca, 0xf149f2ca, 0xf149f2ca, 0xf149f2ca
.long 0xf149f2ca, 0xf149f2ca, 0xf149f2ca, 0xf149f2ca
.long 0xf149f2ca, 0xf149f2ca, 0xf149f2ca, 0xf149f2ca
.long 0xf149f2ca, 0xf149f2ca, 0xf149f2ca, 0xf149f2ca
.long 0xf149f2ca, 0xf149f2ca, 0xf149f2ca, 0xf149f2ca
.long 0xf149f2ca, 0xf149f2ca, 0xf149f2ca, 0xf149f2ca
.long 0xf149f2ca, 0xf149f2ca, 0xf149f2ca, 0xf149f2ca
.long 0xf149f2ca, 0xf149f2ca, 0xf149f2ca, 0xf149f2ca
.long 0xf149f2ca, 0xf149f2ca, 0xf149f2ca, 0xf149f2ca
.long 0xf149f2ca, 0xf149f2ca, 0xf149f2ca, 0xf149f2ca
.long 0xf149f2ca, 0xf149f2ca, 0xf149f2ca, 0xf149f2ca
.long 0x0, 0xf149f2ca, 0xf149f2ca, 0xf149f2ca
.long 0x0, 0x0, 0xf149f2ca, 0xf149f2ca
.long 0x0, 0x0, 0x0, 0xf149f2ca
.long 0x0, 0x0, 0x0, 0x0
.long 0xffff, 0x0, 0x0, 0x0
.long 0xffffffff, 0x0, 0x0, 0x0
.long 0xffffffff, 0xffff, 0x0, 0x0
.long 0xffffffff, 0xffffffff, 0x0, 0x0
.long 0xffffffff, 0xffffffff, 0x0, 0x0
.long 0xffffffff, 0xffffffff, 0x0, 0x0
.long 0xffffffff, 0xffffffff, 0x0, 0x0
.long 0xffffffff, 0xffffffff, 0x0, 0x0
.long 0xffffffff, 0xffffffff, 0xffff, 0x0
.long 0xffffffff, 0xffffffff, 0xffffffff, 0x0
.long 0xffffffff, 0xffffffff, 0xffffffff, 0xffff
.long 0xffffffff, 0xffffffff, 0xffffffff, 0xffffffff
.long 0xffffffff, 0xffffffff, 0xffffffff, 0xffffffff
.long 0xffffffff, 0xffffffff, 0xffffffff, 0xffffffff
.long 0xffffffff, 0xffffffff, 0xffffffff, 0xffffffff
.long 0xffffffff, 0xffffffff, 0xffffffff, 0xffffffff
.long 0xffffffff, 0xffffffff, 0xffffffff, 0xffffffff
.long 0xffffffff, 0xffffffff, 0xffffffff, 0xffffffff
.long 0xffffffff, 0xffffffff, 0xffffffff, 0xffffffff
.long 0xffffffff, 0xffffffff, 0xffffffff, 0xffffffff
.long 0xffffffff, 0xffffffff, 0xffffffff, 0xffffffff
.long 0xffffffff, 0xffffffff, 0xffffffff, 0xffffffff
.long 0xffffffff, 0xffffffff, 0xffffffff, 0xffffffff
.long 0xffffffff, 0xffffffff, 0xffffffff, 0xffffffff
.long 0xffffffff, 0xffffffff, 0xffffffff, 0xffffffff
.long 0xffffffff, 0xffffffff, 0xffffffff, 0xffffffff
.long 0xffffffff, 0xffffffff, 0xffffffff, 0xffffffff
.long 0xffffffff, 0xffffffff, 0xffffffff, 0xffffffff
.long 0xffffffff, 0xffffffff, 0xffffffff, 0xffffffff
.long 0xffffffff, 0xffffffff, 0xffffffff, 0xffffffff
.long 0xffffffff, 0xffffffff, 0xffffffff, 0xffffffff
.long 0xffffffff, 0xffffffff, 0xffffffff, 0xffffffff
.long 0x0, 0x0, 0x0, 0x0
.long 0x0, 0x0, 0x0, 0x0
.long 0x0, 0x0, 0x0, 0x0
.long 0x0, 0x0, 0x0, 0x0
.long 0xffff, 0x0, 0x0, 0x0
.long 0xffffffff, 0x0, 0x0, 0x0
.long 0xffffffff, 0xffff, 0x0, 0x0
.long 0xffffffff, 0xffffffff, 0x0, 0x0
.long 0xffffffff, 0xffffffff, 0x0, 0x0
.long 0xffffffff, 0xffffffff, 0x0, 0x0
.long 0xffffffff, 0xffffffff, 0x0, 0x0
.long 0xffffffff, 0xffffffff, 0x0, 0x0
.long 0xffffffff, 0xffffffff, 0xffff, 0x0
.long 0xffffffff, 0xffffffff, 0xffffffff, 0x0
.long 0xffffffff, 0xffffffff, 0xffffffff, 0xffff
.long 0xffffffff, 0xffffffff, 0xffffffff, 0xffffffff
.long 0xffffffff, 0xffffffff, 0xffffffff, 0xffffffff
.long 0xffffffff, 0xffffffff, 0xffffffff, 0xffffffff
.long 0xffffffff, 0xffffffff, 0xffffffff, 0xffffffff
.long 0xffffffff, 0xffffffff, 0xffffffff, 0xffffffff
.long 0xffffffff, 0xffffffff, 0xffffffff, 0xffffffff
.long 0xffffffff, 0xffffffff, 0xffffffff, 0xffffffff
.long 0xffffffff, 0xffffffff, 0xffffffff, 0xffffffff
.long 0xffffffff, 0xffffffff, 0xffffffff, 0xffffffff
.long 0xffffffff, 0xffffffff, 0xffffffff, 0xffffffff
.long 0xffffffff, 0xffffffff, 0xffffffff, 0xffffffff
.long 0xffffffff, 0xffffffff, 0xffffffff, 0xffffffff
.long 0xffffffff, 0xffffffff, 0xffffffff, 0xffffffff
.long 0xffffffff, 0xffffffff, 0xffffffff, 0xffffffff
.long 0xffffffff, 0xffffffff, 0xffffffff, 0xffffffff
.long 0xffffffff, 0xffffffff, 0xffffffff, 0xffffffff
.long 0xffffffff, 0xffffffff, 0xffffffff, 0xffffffff
.long 0x0, 0x0, 0x0, 0x0
.long 0x0, 0x0, 0x0, 0x0
.long 0x0, 0x0, 0x0, 0x0
.long 0x0, 0x0, 0x0, 0x0
.long 0x0, 0x0, 0x0, 0x0
.long 0x0, 0x0, 0x0, 0x0
.long 0x0, 0x0, 0x0, 0x0
.long 0x0, 0x0, 0x0, 0x0
.long 0x0, 0x0, 0x0, 0x0
.long 0x0, 0x0, 0x0, 0x0
.long 0x0, 0x0, 0x0, 0x0
.long 0x0, 0x0, 0x0, 0x0
.long 0x0, 0x0, 0x0, 0x0
.long 0x0, 0x0, 0x0, 0x0
.long 0x0, 0x0, 0x0, 0x0
.long 0x0, 0x0, 0x0, 0x0
.long 0xffff, 0x0, 0x0, 0x0
.long 0xffffffff, 0x0, 0x0, 0x0
.long 0xffffffff, 0xffff, 0x0, 0x0
.long 0xffffffff, 0xffffffff, 0x0, 0x0
.long 0xffffffff, 0xffffffff, 0x0, 0x0
.long 0xffffffff, 0xffffffff, 0x0, 0x0
.long 0xffffffff, 0xffffffff, 0x0, 0x0
.long 0xffffffff, 0xffffffff, 0x0, 0x0
.long 0xffffffff, 0xffffffff, 0xffff, 0x0
.long 0xffffffff, 0xffffffff, 0xffffffff, 0x0
.long 0xffffffff, 0xffffffff, 0xffffffff, 0xffff
.long 0xffffffff, 0xffffffff, 0xffffffff, 0xffffffff
.long 0xffffffff, 0xffffffff, 0xffffffff, 0xffffffff
.long 0xffffffff, 0xffffffff, 0xffffffff, 0xffffffff
.long 0xffffffff, 0xffffffff, 0xffffffff, 0xffffffff
.long 0xffffffff, 0xffffffff, 0xffffffff, 0xffffffff
.long 0x0, 0x0, 0x0, 0x0
.long 0x0, 0x0, 0x0, 0x0
.long 0x0, 0x0, 0x0, 0x0
.long 0x0, 0x0, 0x0, 0x0
.long 0x0, 0x0, 0x0, 0x0
.long 0x0, 0x0, 0x0, 0x0
.long 0x0, 0x0, 0x0, 0x0
.long 0x0, 0x0, 0x0, 0x0
.long 0x0, 0x0, 0x0, 0x0
.long 0x0, 0x0, 0x0, 0x0
.long 0x0, 0x0, 0x0, 0x0
.long 0x0, 0x0, 0x0, 0x0
.long 0x0, 0x0, 0x0, 0x0
.long 0x0, 0x0, 0x0, 0x0
.long 0x0, 0x0, 0x0, 0x0
.long 0x0, 0x0, 0x0, 0x0
.long 0x0, 0x0, 0x0, 0x0
.long 0x0, 0x0, 0x0, 0x0
.long 0x0, 0x0, 0x0, 0x0
.long 0x0, 0x0, 0x0, 0x0
.long 0xffff, 0x0, 0x0, 0x0
.long 0xffffffff, 0x0, 0x0, 0x0
.long 0xffffffff, 0xffff, 0x0, 0x0
.long 0xffffffff, 0xffffffff, 0x0, 0x0
.long 0xffffffff, 0xffffffff, 0x0, 0x0
.long 0xffffffff, 0xffffffff, 0x0, 0x0
.long 0xffffffff, 0xffffffff, 0x0, 0x0
.long 0xffffffff, 0xffffffff, 0x0, 0x0
.long 0xffffffff, 0xffffffff, 0xffff, 0x0
.long 0xffffffff, 0xffffffff, 0xffffffff, 0x0
.long 0xffffffff, 0xffffffff, 0xffffffff, 0xffff
.long 0xffffffff, 0xffffffff, 0xffffffff, 0xffffffff
L_codeend:
.section .rodata,"a"
.p2align 6
.amdhsa_kernel concat_heads__sliding_block__ssm_conv_h3__prompt_kernel
  .amdhsa_next_free_vgpr 512
  .amdhsa_next_free_sgpr 102
  .amdhsa_accum_offset 256
  .amdhsa_group_segment_fixed_size 0
  .amdhsa_kernarg_size 96
  .amdhsa_user_sgpr_count 2
  .amdhsa_user_sgpr_kernarg_segment_ptr 1
  .amdhsa_system_sgpr_workgroup_id_x 1
.end_amdhsa_kernel
```
